```python
import torch

def _softmax(x, axis=-1):
    return torch.softmax(x, dim=axis)

def _gelu(x):
    return torch.nn.functional.gelu(x, approximate='tanh')

def _silu(x):
    return torch.nn.functional.silu(x)

def _sigmoid(x):
    return torch.sigmoid(x)

def _layernorm(x, axis=-1, eps=1e-05):
    m = x.mean(dim=axis, keepdim=True)
    v = x.var(dim=axis, keepdim=True, unbiased=False)
    return (x - m) / torch.sqrt(v + eps)

def _scatter_add(tgt, idx, src, axis=0):
    return tgt.clone().index_add_(axis, idx, src)

def _segment_sum(src, seg, n):
    out = torch.zeros((n,) + src.shape[1:], dtype=src.dtype)
    return out.index_add_(0, seg, src)

def _pad(x, pw):
    flat = tuple((v for pair in reversed(pw) for v in pair))
    return torch.nn.functional.pad(x, flat)
kernel_name = 'gated_mix__ssm_conv_s4d__mixer_gmlp__prompt'

def setup_inputs():

    _w = lambda a: (lambda t: t.to(torch.bfloat16) if t.is_floating_point() else t)(torch.as_tensor(a))

    def _A_setup():
        Bsz, L, D, N = (1, 2048, 448, 256)
        return {'u': _w((lambda *s: torch.randn(*s, dtype=torch.bfloat16) * 0.05)(Bsz, L, D)), 'log_A_real': _w((lambda *s: torch.randn(*s, dtype=torch.bfloat16) * 3.2)(D, N) * 0.5), 'A_imag': _w((lambda *s: torch.randn(*s, dtype=torch.bfloat16) * 0.05)(D, N) * 3.14), 'C_real': _w((lambda *s: torch.randn(*s, dtype=torch.bfloat16) * 1.6)(D, N) / N ** 0.5), 'C_imag': _w((lambda *s: torch.randn(*s, dtype=torch.bfloat16) * 1.6)(D, N) / N ** 0.5), 'log_dt': _w((lambda *s: torch.randn(*s, dtype=torch.bfloat16) * 0.05)(D) * 0.5 - 4.0), 'D_skip': _w((lambda *s: torch.randn(*s, dtype=torch.bfloat16) * 0.2)(D))}
    _A_in = _A_setup()

    def _B_setup():
        B, S, D, F = (1, 2048, 448, 1792)
        Fh = F // 2
        return {'x': _w((lambda *s: torch.randn(*s, dtype=torch.bfloat16) * 0.05)(B, S, D)), 'w_in': _w((lambda *s: torch.randn(*s, dtype=torch.bfloat16) * 0.2)(D, 2 * Fh)), 'w_sp': _w(0.01 * (lambda *s: torch.randn(*s, dtype=torch.bfloat16) * 0.2)(S, S)), 'b_sp': _w(1.0 + 0.01 * (lambda *s: torch.randn(*s, dtype=torch.bfloat16) * 0.05)(S)), 'w_out': _w((lambda *s: torch.randn(*s, dtype=torch.bfloat16) * 0.05)(Fh, D))}
    _B_in = _B_setup()
    return {'A_u': _A_in['u'], 'A_log_A_real': _A_in['log_A_real'], 'A_A_imag': _A_in['A_imag'], 'A_C_real': _A_in['C_real'], 'A_C_imag': _A_in['C_imag'], 'A_log_dt': _A_in['log_dt'], 'A_D_skip': _A_in['D_skip'], 'B_x': _B_in['x'], 'B_w_in': _B_in['w_in'], 'B_w_sp': _B_in['w_sp'], 'B_b_sp': _B_in['b_sp'], 'B_w_out': _B_in['w_out'], 'gate_w': _w((lambda *s: torch.randn(*s, dtype=torch.bfloat16) * 0.05)(448) * 16.0)}

def reference(A_u, A_log_A_real, A_A_imag, A_C_real, A_C_imag, A_log_dt, A_D_skip, B_x, B_w_in, B_w_sp, B_b_sp, B_w_out, gate_w):

    def _A_ref(u, log_A_real, A_imag, C_real, C_imag, log_dt, D_skip):
        L = u.shape[1]
        dt = torch.exp(log_dt)
        A = -torch.exp(log_A_real) + 1j * A_imag
        C = (C_real + 1j * C_imag) * dt[:, None]
        pos = (lambda x, dt: x.to(dt))(torch.arange(L), log_dt.dtype)
        P = torch.exp((A * dt[:, None])[:, :, None] * pos[None, None, :])
        K = 2.0 * torch.einsum('dn,dnl->dl', C, P).real
        L2 = 2 * L
        u_t = (lambda x, *d: x.permute(*d))(u, 0, 2, 1)
        Kf = (lambda x, *a, **k: torch.fft.rfft(x.float(), *a, **k))(K, L2)
        Uf = (lambda x, *a, **k: torch.fft.rfft(x.float(), *a, **k))(u_t, L2)
        y = (lambda x, *a, **k: torch.fft.irfft(x, *a, **k).to(torch.bfloat16))(Uf * Kf[None, :, :], L2)[:, :, :L]
        y = (lambda x, *d: x.permute(*d))(y, 0, 2, 1)
        return y + u * D_skip[None, None, :]

    def _B_ref(x, w_in, w_sp, b_sp, w_out):
        B, S, D = x.shape
        F = w_in.shape[-1]
        Fh = F // 2
        z = _gelu(torch.einsum('bsd,df->bsf', x, w_in))
        z1 = z[..., :Fh].clone()
        z2 = _layernorm(z[..., Fh:], axis=-1)
        g = torch.einsum('ts,bsf->btf', w_sp, z2) + b_sp[None, :, None]
        return torch.einsum('bsf,fd->bsd', z1 * g, w_out)
    x = A_u
    g = _sigmoid((x * gate_w).sum(-1, keepdims=True))
    a = _A_ref(x, A_log_A_real, A_A_imag, A_C_real, A_C_imag, A_log_dt, A_D_skip)
    b = _B_ref(x, B_w_in, B_w_sp, B_b_sp, B_w_out)
    return g * a + (1 - g) * b
```

```asm
; @launch grid=(256,1,1) block=(512,1,1) lds=163840
.amdgcn_target "amdgcn-amd-amdhsa--gfx950"
.text
.p2align 8
.globl gated_mix__ssm_conv_s4d__mixer_gmlp__prompt_kernel
.type gated_mix__ssm_conv_s4d__mixer_gmlp__prompt_kernel,@function
gated_mix__ssm_conv_s4d__mixer_gmlp__prompt_kernel:
    s_cmp_ge_u32 s2, 256
    s_cbranch_scc1 L_end
    s_load_dwordx2 s[8:9], s[0:1], 0
    s_load_dwordx2 s[16:17], s[0:1], 64
    s_load_dwordx2 s[12:13], s[0:1], 120
    s_load_dwordx8 s[36:43], s[0:1], 8
    s_load_dwordx4 s[44:47], s[0:1], 40
    s_load_dwordx8 s[48:55], s[0:1], 72
    s_load_dwordx2 s[26:27], s[0:1], 104
    v_lshrrev_b32 v1, 6, v0
    v_and_b32 v0, 63, v0
    v_readfirstlane_b32 s3, v1
    s_lshr_b32 s30, s2, 3
    s_and_b32 s29, s2, 1
    s_lshl_b32 s29, s29, 2
    s_and_b32 s31, s30, 3
    s_add_u32 s31, s31, s29
    s_lshr_b32 s35, s30, 3
    s_add_u32 s29, s29, s35
    s_and_b32 s35, s30, 7
    s_cmp_lt_u32 s30, 24
    s_cselect_b32 s31, s35, s31
    s_cselect_b32 s29, s29, 3
    s_cmp_ge_u32 s30, 28
    s_cselect_b32 s29, 7, s29
    s_and_b32 s28, s2, 6
    s_lshl_b32 s28, s28, 2
    s_add_u32 s28, s28, s31
    s_min_u32 s31, s31, 6
    s_and_b32 s32, s3, 3
    v_and_b32 v8, 15, v0
    v_lshrrev_b32 v9, 4, v0
    v_lshlrev_b32 v10, 1, v9
    v_xor_b32 v10, v10, v8
    v_lshlrev_b32 v10, 4, v10
    v_mul_u32_u24 v11, 3584, v9
    v_add_u32 v10, v10, v11
    v_add_u32 v11, 14336, v10
    v_xor_b32 v12, 128, v10
    v_add_u32 v12, 28672, v12
    v_add_u32 v13, 14336, v12
    s_mul_i32 s33, s32, 57344
    s_lshl_b32 s34, s29, 8
    s_add_u32 s33, s33, s34
    s_add_u32 s33, s33, 1792
    s_lshl_b32 s34, s32, 12
    v_lshrrev_b32 v21, 3, v0
    v_and_b32 v20, 7, v0
    v_lshrrev_b32 v5, 1, v21
    v_xor_b32 v20, v20, v5
    v_lshlrev_b32 v20, 4, v20
    v_mul_u32_u24 v6, 896, v21
    v_add_u32 v6, v6, v20
    v_xor_b32 v7, 64, v6
    v_add_u32 v4, 7168, v7
    s_lshl_b32 s24, s28, 2
    s_add_u32 s24, s24, s32
    s_mul_i32 s24, s24, 14336
    s_lshl_b32 s25, s32, 11
    s_add_u32 s25, s25, 65536
    s_nop 0
    s_mov_b32 s10, 1835008
    s_mov_b32 s11, 0x20000
    s_mov_b32 s14, 0xaf0000
    s_mov_b32 s15, 0x20000
    s_mov_b32 s18, 1605632
    s_mov_b32 s19, 0x20000
    s_mov_b32 s5, 0xae6000
    s_cmp_eq_u32 s29, 7
    s_waitcnt lgkmcnt(0)
    s_load_dword s4, s[12:13], s5
    s_cbranch_scc1 L_helper
    s_cmp_lt_u32 s3, 4
    s_cbranch_scc1 L_A
    v_mul_u32_u24 v1, 896, v8
    s_lshl_b32 s20, s29, 7
    s_add_u32 s20, s20, s24
    s_mov_b64 exec, 0xffff
    buffer_load_dword v209, v1, s[8:11], s20 offen
    s_mov_b64 exec, -1
    s_mul_i32 s20, s28, 7
    s_add_u32 s20, s20, s29
    s_lshr_b32 s21, s32, 1
    s_and_b32 s22, s32, 1
    s_lshl_b32 s23, s20, 2
    s_load_dword s30, s[46:47], s23
    s_lshl_b32 s20, s20, 1
    s_add_u32 s20, s20, s21
    s_lshl_b32 s23, s20, 9
    s_lshl_b32 s35, s22, 8
    s_add_u32 s23, s23, s35
    v_lshlrev_b32 v1, 1, v0
    v_add_u32 v1, s23, v1
    global_load_ushort v200, v1, s[36:37] offset:0
    global_load_ushort v201, v1, s[38:39] offset:0
    global_load_ushort v202, v1, s[40:41] offset:0
    global_load_ushort v203, v1, s[42:43] offset:0
    global_load_ushort v204, v1, s[36:37] offset:128
    global_load_ushort v205, v1, s[38:39] offset:128
    global_load_ushort v206, v1, s[40:41] offset:128
    global_load_ushort v207, v1, s[42:43] offset:128
    s_lshl_b32 s23, s20, 1
    v_mov_b32 v1, s23
    global_load_ushort v208, v1, s[44:45]
    s_branch L_B
L_A:
    s_add_u32 s35, s31, 0
    s_cmp_ge_u32 s35, 7
    s_cselect_b32 s63, 7, 0
    s_sub_u32 s35, s35, s63
    s_lshl_b32 s63, s35, 7
    s_add_u32 s63, s63, s24
    s_add_u32 m0, s25, 0
    s_mul_i32 s35, s35, 229376
    buffer_load_dwordx4 v6, s[8:11], s63 offen lds
    s_add_u32 m0, s25, 1024
    s_add_u32 s35, s35, s33
    buffer_load_dwordx4 v4, s[8:11], s63 offen lds
    s_add_u32 m0, s34, 0
    s_nop 0
    buffer_load_dwordx4 v10, s[16:19], s35 offen lds
    s_add_u32 m0, s34, 1024
    s_nop 0
    buffer_load_dwordx4 v11, s[16:19], s35 offen lds
    s_add_u32 m0, s34, 2048
    s_nop 0
    buffer_load_dwordx4 v12, s[16:19], s35 offen lds
    s_add_u32 m0, s34, 3072
    s_nop 0
    buffer_load_dwordx4 v13, s[16:19], s35 offen lds
    s_add_u32 s35, s31, 1
    s_cmp_ge_u32 s35, 7
    s_cselect_b32 s63, 7, 0
    s_sub_u32 s35, s35, s63
    s_lshl_b32 s63, s35, 7
    s_add_u32 s63, s63, s24
    s_add_u32 m0, s25, 8192
    s_mul_i32 s35, s35, 229376
    buffer_load_dwordx4 v6, s[8:11], s63 offen lds
    s_add_u32 m0, s25, 9216
    s_add_u32 s35, s35, s33
    buffer_load_dwordx4 v4, s[8:11], s63 offen lds
    s_add_u32 m0, s34, 16384
    s_nop 0
    buffer_load_dwordx4 v10, s[16:19], s35 offen lds
    s_add_u32 m0, s34, 17408
    s_nop 0
    buffer_load_dwordx4 v11, s[16:19], s35 offen lds
    s_add_u32 m0, s34, 18432
    s_nop 0
    buffer_load_dwordx4 v12, s[16:19], s35 offen lds
    s_add_u32 m0, s34, 19456
    s_nop 0
    buffer_load_dwordx4 v13, s[16:19], s35 offen lds
    s_setprio 1
    s_mov_b32 s36, s50
    s_mov_b32 s37, s51
    s_mov_b32 s38, 0x1000
    s_mov_b32 s39, 0x20000
    v_lshlrev_b32 v1, 1, v8
    s_lshl_b32 s35, s28, 7
    buffer_load_ushort v228, v1, s[36:39], s35 offen offset:0
    buffer_load_ushort v229, v1, s[36:39], s35 offen offset:32
    buffer_load_ushort v230, v1, s[36:39], s35 offen offset:64
    buffer_load_ushort v231, v1, s[36:39], s35 offen offset:96
    v_lshlrev_b32 v2, 4, v0
    v_mov_b32 v22, 163792
    s_lshl_b32 s35, s3, 2
    v_add_u32 v29, s35, v22
    v_mov_b32 v23, 0
    ds_write_b32 v29, v23
    ds_write_b32 v29, v23 offset:16
    v_mov_b32 v23, 6
    ds_write_b32 v29, v23 offset:32
    v_lshrrev_b32 v14, 1, v8
    v_xor_b32 v14, v14, v9
    v_lshlrev_b32 v14, 4, v14
    v_lshl_add_u32 v14, v8, 7, v14
    v_add_u32 v14, s25, v14
    v_xor_b32 v15, 64, v14
    v_lshrrev_b32 v16, 2, v0
    v_and_b32 v17, 7, v16
    v_lshlrev_b32 v17, 5, v17
    v_and_b32 v16, 3, v16
    v_lshl_add_u32 v16, v9, 3, v16
    v_and_b32 v19, 3, v0
    v_lshlrev_b32 v18, 3, v19
    v_lshl_add_u32 v18, v16, 8, v18
    v_xor_b32 v168, 0, v17
    v_add_u32 v168, v168, v18
    v_xor_b32 v169, 32, v17
    v_add_u32 v169, v169, v18
    v_xor_b32 v170, 64, v17
    v_add_u32 v170, v170, v18
    v_xor_b32 v171, 96, v17
    v_add_u32 v171, v171, v18
    v_xor_b32 v172, 128, v17
    v_add_u32 v172, v172, v18
    v_xor_b32 v173, 160, v17
    v_add_u32_e64 v173, v173, v18
    v_xor_b32 v174, 192, v17
    v_add_u32 v174, v174, v18
    v_xor_b32 v175, 224, v17
    v_add_u32 v175, v175, v18
    v_mov_b32 v24, 0xbdd2d3e8
    v_mov_b32 v25, 0xbdd2d3e8
    v_mov_b32 v26, 0xc0135761
    v_mov_b32 v27, 0xc0135761
    v_mov_b32 v30, 1.0
    v_mov_b32 v31, 1.0
    v_lshrrev_b32 v224, 2, v0
    v_mul_u32_u24 v224, 3584, v224
    v_lshrrev_b32 v225, 4, v0
    v_and_b32 v225, 2, v225
    v_xor_b32 v225, v225, v0
    v_and_b32_e64 v225, 3, v225
    v_lshl_add_u32 v224, v225, 4, v224
    v_add_u32 v225, 57344, v224
    s_lshl_b32 s38, s29, 8
    s_lshl_b32 s35, s32, 6
    s_add_u32 s38, s38, s35
    s_lshl_b32 s40, s32, 11
    v_lshlrev_b32 v226, 6, v16
    v_lshl_add_u32 v226, v19, 3, v226
    v_and_b32 v227, 1, v9
    v_lshl_add_u32 v226, v227, 5, v226
    v_xor_b32 v227, 32, v226
    v_add_u32 v226, s40, v226
    v_add_u32 v227, s40, v227
    s_lshl_b32 s41, s31, 1
    s_add_u32 s41, s41, 8
    s_cmp_ge_u32 s41, 14
    s_cselect_b32 s35, 14, 0
    s_sub_u32 s41, s41, s35
    s_lshl_b32 s35, s32, 2
    v_add_u32 v5, s35, v22
    s_waitcnt vmcnt(10) lgkmcnt(0)
    s_waitcnt lgkmcnt(0)
    s_mul_i32 s4, s4, 0x9E3779B1
    s_add_u32 s4, s4, 0x7F4A7C15
    v_mov_b32 v28, s4
    s_barrier
    ds_read_b128 v[32:35], v14 offset:0
    ds_read_b64_tr_b16 v[88:89], v168 offset:0
    ds_read_b64_tr_b16 v[90:91], v168 offset:1024
    ds_read_b64_tr_b16 v[92:93], v169 offset:0
    ds_read_b64_tr_b16 v[94:95], v169 offset:1024
    ds_read_b64_tr_b16 v[96:97], v170 offset:0
    ds_read_b64_tr_b16 v[98:99], v170 offset:1024
    ds_read_b64_tr_b16 v[100:101], v171 offset:0
    ds_read_b64_tr_b16 v[102:103], v171 offset:1024
    s_waitcnt lgkmcnt(4)
    v_mfma_f32_16x16x32_bf16 v[120:123], v[32:35], v[88:91], 0
    ds_read_b64_tr_b16 v[104:105], v172 offset:0
    ds_read_b64_tr_b16 v[106:107], v172 offset:1024
    v_mfma_f32_16x16x32_bf16 v[124:127], v[32:35], v[92:95], 0
    ds_read_b64_tr_b16 v[108:109], v173 offset:0
    ds_read_b64_tr_b16 v[110:111], v173 offset:1024
    s_waitcnt lgkmcnt(4)
    v_mfma_f32_16x16x32_bf16 v[128:131], v[32:35], v[96:99], 0
    ds_read_b64_tr_b16 v[112:113], v174 offset:0
    ds_read_b64_tr_b16 v[114:115], v174 offset:1024
    v_mfma_f32_16x16x32_bf16 v[132:135], v[32:35], v[100:103], 0
    ds_read_b64_tr_b16 v[116:117], v175 offset:0
    ds_read_b64_tr_b16 v[118:119], v175 offset:1024
    ds_read_b128 v[36:39], v15 offset:0
    s_waitcnt lgkmcnt(5)
    v_mfma_f32_16x16x32_bf16 v[136:139], v[32:35], v[104:107], 0
    ds_read_b64_tr_b16 v[88:89], v168 offset:8192
    ds_read_b64_tr_b16 v[90:91], v168 offset:9216
    v_mfma_f32_16x16x32_bf16 v[140:143], v[32:35], v[108:111], 0
    ds_read_b64_tr_b16 v[92:93], v169 offset:8192
    ds_read_b64_tr_b16 v[94:95], v169 offset:9216
    s_waitcnt lgkmcnt(4)
    v_mfma_f32_16x16x32_bf16 v[144:147], v[32:35], v[112:115], 0
    ds_read_b64_tr_b16 v[96:97], v170 offset:8192
    ds_read_b64_tr_b16 v[98:99], v170 offset:9216
    v_mfma_f32_16x16x32_bf16 v[148:151], v[32:35], v[116:119], 0
    ds_read_b64_tr_b16 v[100:101], v171 offset:8192
    ds_read_b64_tr_b16 v[102:103], v171 offset:9216
    s_waitcnt lgkmcnt(4)
    v_mfma_f32_16x16x32_bf16 v[120:123], v[36:39], v[88:91], v[120:123]
    ds_read_b64_tr_b16 v[104:105], v172 offset:8192
    ds_read_b64_tr_b16 v[106:107], v172 offset:9216
    v_mfma_f32_16x16x32_bf16 v[124:127], v[36:39], v[92:95], v[124:127]
    ds_read_b64_tr_b16 v[108:109], v173 offset:8192
    ds_read_b64_tr_b16 v[110:111], v173 offset:9216
    s_waitcnt lgkmcnt(4)
    v_mfma_f32_16x16x32_bf16 v[128:131], v[36:39], v[96:99], v[128:131]
    ds_read_b64_tr_b16 v[112:113], v174 offset:8192
    ds_read_b64_tr_b16 v[114:115], v174 offset:9216
    v_mfma_f32_16x16x32_bf16 v[132:135], v[36:39], v[100:103], v[132:135]
    ds_read_b64_tr_b16 v[116:117], v175 offset:8192
    ds_read_b64_tr_b16 v[118:119], v175 offset:9216
    s_waitcnt lgkmcnt(0) vmcnt(0)
    s_barrier
    ds_read_b128 v[32:35], v14 offset:8192
    v_mfma_f32_16x16x32_bf16 v[136:139], v[36:39], v[104:107], v[136:139]
    ds_read_b64_tr_b16 v[88:89], v168 offset:16384
    ds_read_b64_tr_b16 v[90:91], v168 offset:17408
    v_mfma_f32_16x16x32_bf16 v[140:143], v[36:39], v[108:111], v[140:143]
    ds_read_b64_tr_b16 v[92:93], v169 offset:16384
    ds_read_b64_tr_b16 v[94:95], v169 offset:17408
    v_mfma_f32_16x16x32_bf16 v[144:147], v[36:39], v[112:115], v[144:147]
    ds_read_b64_tr_b16 v[96:97], v170 offset:16384
    ds_read_b64_tr_b16 v[98:99], v170 offset:17408
    v_mfma_f32_16x16x32_bf16 v[148:151], v[36:39], v[116:119], v[148:151]
    ds_read_b64_tr_b16 v[100:101], v171 offset:16384
    ds_read_b64_tr_b16 v[102:103], v171 offset:17408
    s_waitcnt lgkmcnt(4)
    v_mfma_f32_16x16x32_bf16 v[120:123], v[32:35], v[88:91], v[120:123]
    ds_read_b64_tr_b16 v[104:105], v172 offset:16384
    ds_read_b64_tr_b16 v[106:107], v172 offset:17408
    v_mfma_f32_16x16x32_bf16 v[124:127], v[32:35], v[92:95], v[124:127]
    ds_read_b64_tr_b16 v[108:109], v173 offset:16384
    ds_read_b64_tr_b16 v[110:111], v173 offset:17408
    s_waitcnt lgkmcnt(4)
    v_mfma_f32_16x16x32_bf16 v[128:131], v[32:35], v[96:99], v[128:131]
    ds_read_b64_tr_b16 v[112:113], v174 offset:16384
    ds_read_b64_tr_b16 v[114:115], v174 offset:17408
    v_mfma_f32_16x16x32_bf16 v[132:135], v[32:35], v[100:103], v[132:135]
    ds_read_b64_tr_b16 v[116:117], v175 offset:16384
    ds_read_b64_tr_b16 v[118:119], v175 offset:17408
    ds_read_b128 v[36:39], v15 offset:8192
    s_waitcnt lgkmcnt(5)
    v_mfma_f32_16x16x32_bf16 v[136:139], v[32:35], v[104:107], v[136:139]
    ds_read_b64_tr_b16 v[88:89], v168 offset:24576
    ds_read_b64_tr_b16 v[90:91], v168 offset:25600
    v_mfma_f32_16x16x32_bf16 v[140:143], v[32:35], v[108:111], v[140:143]
    ds_read_b64_tr_b16 v[92:93], v169 offset:24576
    ds_read_b64_tr_b16 v[94:95], v169 offset:25600
    s_waitcnt lgkmcnt(4)
    v_mfma_f32_16x16x32_bf16 v[144:147], v[32:35], v[112:115], v[144:147]
    ds_read_b64_tr_b16 v[96:97], v170 offset:24576
    ds_read_b64_tr_b16 v[98:99], v170 offset:25600
    v_mfma_f32_16x16x32_bf16 v[148:151], v[32:35], v[116:119], v[148:151]
    ds_read_b64_tr_b16 v[100:101], v171 offset:24576
    ds_read_b64_tr_b16 v[102:103], v171 offset:25600
    s_waitcnt lgkmcnt(4)
    v_mfma_f32_16x16x32_bf16 v[120:123], v[36:39], v[88:91], v[120:123]
    ds_read_b64_tr_b16 v[104:105], v172 offset:24576
    ds_read_b64_tr_b16 v[106:107], v172 offset:25600
    v_mfma_f32_16x16x32_bf16 v[124:127], v[36:39], v[92:95], v[124:127]
    ds_read_b64_tr_b16 v[108:109], v173 offset:24576
    ds_read_b64_tr_b16 v[110:111], v173 offset:25600
    s_waitcnt lgkmcnt(4)
    v_mfma_f32_16x16x32_bf16 v[128:131], v[36:39], v[96:99], v[128:131]
    ds_read_b64_tr_b16 v[112:113], v174 offset:24576
    ds_read_b64_tr_b16 v[114:115], v174 offset:25600
    v_mfma_f32_16x16x32_bf16 v[132:135], v[36:39], v[100:103], v[132:135]
    ds_read_b64_tr_b16 v[116:117], v175 offset:24576
    ds_read_b64_tr_b16 v[118:119], v175 offset:25600
    s_waitcnt lgkmcnt(0)
    s_barrier
    ds_read_b128 v[32:35], v14 offset:16384
    v_mfma_f32_16x16x32_bf16 v[136:139], v[36:39], v[104:107], v[136:139]
    ds_read_b64_tr_b16 v[88:89], v168 offset:32768
    ds_read_b64_tr_b16 v[90:91], v168 offset:33792
    v_mfma_f32_16x16x32_bf16 v[140:143], v[36:39], v[108:111], v[140:143]
    ds_read_b64_tr_b16 v[92:93], v169 offset:32768
    ds_read_b64_tr_b16 v[94:95], v169 offset:33792
    v_mfma_f32_16x16x32_bf16 v[144:147], v[36:39], v[112:115], v[144:147]
    ds_read_b64_tr_b16 v[96:97], v170 offset:32768
    ds_read_b64_tr_b16 v[98:99], v170 offset:33792
    v_mfma_f32_16x16x32_bf16 v[148:151], v[36:39], v[116:119], v[148:151]
    ds_read_b64_tr_b16 v[100:101], v171 offset:32768
    ds_read_b64_tr_b16 v[102:103], v171 offset:33792
    s_waitcnt lgkmcnt(4)
    v_mfma_f32_16x16x32_bf16 v[120:123], v[32:35], v[88:91], v[120:123]
    ds_read_b64_tr_b16 v[104:105], v172 offset:32768
    ds_read_b64_tr_b16 v[106:107], v172 offset:33792
    v_mfma_f32_16x16x32_bf16 v[124:127], v[32:35], v[92:95], v[124:127]
    ds_read_b64_tr_b16 v[108:109], v173 offset:32768
    ds_read_b64_tr_b16 v[110:111], v173 offset:33792
    s_waitcnt lgkmcnt(4)
    v_mfma_f32_16x16x32_bf16 v[128:131], v[32:35], v[96:99], v[128:131]
    ds_read_b64_tr_b16 v[112:113], v174 offset:32768
    ds_read_b64_tr_b16 v[114:115], v174 offset:33792
    v_mfma_f32_16x16x32_bf16 v[132:135], v[32:35], v[100:103], v[132:135]
    ds_read_b64_tr_b16 v[116:117], v175 offset:32768
    ds_read_b64_tr_b16 v[118:119], v175 offset:33792
    ds_read_b128 v[36:39], v15 offset:16384
    s_waitcnt lgkmcnt(5)
    v_mfma_f32_16x16x32_bf16 v[136:139], v[32:35], v[104:107], v[136:139]
    ds_read_b64_tr_b16 v[88:89], v168 offset:40960
    ds_read_b64_tr_b16 v[90:91], v168 offset:41984
    v_mfma_f32_16x16x32_bf16 v[140:143], v[32:35], v[108:111], v[140:143]
    ds_read_b64_tr_b16 v[92:93], v169 offset:40960
    ds_read_b64_tr_b16 v[94:95], v169 offset:41984
    s_waitcnt lgkmcnt(4)
    v_mfma_f32_16x16x32_bf16 v[144:147], v[32:35], v[112:115], v[144:147]
    ds_read_b64_tr_b16 v[96:97], v170 offset:40960
    ds_read_b64_tr_b16 v[98:99], v170 offset:41984
    v_mfma_f32_16x16x32_bf16 v[148:151], v[32:35], v[116:119], v[148:151]
    ds_read_b64_tr_b16 v[100:101], v171 offset:40960
    ds_read_b64_tr_b16 v[102:103], v171 offset:41984
    s_waitcnt lgkmcnt(4)
    v_mfma_f32_16x16x32_bf16 v[120:123], v[36:39], v[88:91], v[120:123]
    ds_read_b64_tr_b16 v[104:105], v172 offset:40960
    ds_read_b64_tr_b16 v[106:107], v172 offset:41984
    v_mfma_f32_16x16x32_bf16 v[124:127], v[36:39], v[92:95], v[124:127]
    ds_read_b64_tr_b16 v[108:109], v173 offset:40960
    ds_read_b64_tr_b16 v[110:111], v173 offset:41984
    s_waitcnt lgkmcnt(4)
    v_mfma_f32_16x16x32_bf16 v[128:131], v[36:39], v[96:99], v[128:131]
    ds_read_b64_tr_b16 v[112:113], v174 offset:40960
    ds_read_b64_tr_b16 v[114:115], v174 offset:41984
    v_mfma_f32_16x16x32_bf16 v[132:135], v[36:39], v[100:103], v[132:135]
    ds_read_b64_tr_b16 v[116:117], v175 offset:40960
    ds_read_b64_tr_b16 v[118:119], v175 offset:41984
    s_waitcnt lgkmcnt(0)
    s_barrier
    ds_read_b128 v[32:35], v14 offset:24576
    v_mfma_f32_16x16x32_bf16 v[136:139], v[36:39], v[104:107], v[136:139]
    ds_read_b64_tr_b16 v[88:89], v168 offset:49152
    ds_read_b64_tr_b16 v[90:91], v168 offset:50176
    v_mfma_f32_16x16x32_bf16 v[140:143], v[36:39], v[108:111], v[140:143]
    ds_read_b64_tr_b16 v[92:93], v169 offset:49152
    ds_read_b64_tr_b16 v[94:95], v169 offset:50176
    v_mfma_f32_16x16x32_bf16 v[144:147], v[36:39], v[112:115], v[144:147]
    ds_read_b64_tr_b16 v[96:97], v170 offset:49152
    ds_read_b64_tr_b16 v[98:99], v170 offset:50176
    v_mfma_f32_16x16x32_bf16 v[148:151], v[36:39], v[116:119], v[148:151]
    ds_read_b64_tr_b16 v[100:101], v171 offset:49152
    ds_read_b64_tr_b16 v[102:103], v171 offset:50176
    s_waitcnt lgkmcnt(4)
    v_mfma_f32_16x16x32_bf16 v[120:123], v[32:35], v[88:91], v[120:123]
    ds_read_b64_tr_b16 v[104:105], v172 offset:49152
    ds_read_b64_tr_b16 v[106:107], v172 offset:50176
    v_mfma_f32_16x16x32_bf16 v[124:127], v[32:35], v[92:95], v[124:127]
    ds_read_b64_tr_b16 v[108:109], v173 offset:49152
    ds_read_b64_tr_b16 v[110:111], v173 offset:50176
    s_waitcnt lgkmcnt(4)
    v_mfma_f32_16x16x32_bf16 v[128:131], v[32:35], v[96:99], v[128:131]
    ds_read_b64_tr_b16 v[112:113], v174 offset:49152
    ds_read_b64_tr_b16 v[114:115], v174 offset:50176
    v_mfma_f32_16x16x32_bf16 v[132:135], v[32:35], v[100:103], v[132:135]
    ds_read_b64_tr_b16 v[116:117], v175 offset:49152
    ds_read_b64_tr_b16 v[118:119], v175 offset:50176
    ds_read_b128 v[36:39], v15 offset:24576
    s_waitcnt lgkmcnt(5)
    v_mfma_f32_16x16x32_bf16 v[136:139], v[32:35], v[104:107], v[136:139]
    ds_read_b64_tr_b16 v[88:89], v168 offset:57344
    ds_read_b64_tr_b16 v[90:91], v168 offset:58368
    v_mfma_f32_16x16x32_bf16 v[140:143], v[32:35], v[108:111], v[140:143]
    ds_read_b64_tr_b16 v[92:93], v169 offset:57344
    ds_read_b64_tr_b16 v[94:95], v169 offset:58368
    s_waitcnt lgkmcnt(4)
    v_mfma_f32_16x16x32_bf16 v[144:147], v[32:35], v[112:115], v[144:147]
    ds_read_b64_tr_b16 v[96:97], v170 offset:57344
    ds_read_b64_tr_b16 v[98:99], v170 offset:58368
    v_mfma_f32_16x16x32_bf16 v[148:151], v[32:35], v[116:119], v[148:151]
    ds_read_b64_tr_b16 v[100:101], v171 offset:57344
    ds_read_b64_tr_b16 v[102:103], v171 offset:58368
    s_waitcnt lgkmcnt(4)
    v_mfma_f32_16x16x32_bf16 v[120:123], v[36:39], v[88:91], v[120:123]
    ds_read_b64_tr_b16 v[104:105], v172 offset:57344
    ds_read_b64_tr_b16 v[106:107], v172 offset:58368
    v_mfma_f32_16x16x32_bf16 v[124:127], v[36:39], v[92:95], v[124:127]
    ds_read_b64_tr_b16 v[108:109], v173 offset:57344
    ds_read_b64_tr_b16 v[110:111], v173 offset:58368
    s_waitcnt lgkmcnt(4)
    v_mfma_f32_16x16x32_bf16 v[128:131], v[36:39], v[96:99], v[128:131]
    ds_read_b64_tr_b16 v[112:113], v174 offset:57344
    ds_read_b64_tr_b16 v[114:115], v174 offset:58368
    v_mfma_f32_16x16x32_bf16 v[132:135], v[36:39], v[100:103], v[132:135]
    ds_read_b64_tr_b16 v[116:117], v175 offset:57344
    ds_read_b64_tr_b16 v[118:119], v175 offset:58368
    s_waitcnt lgkmcnt(0)
    s_barrier
    ds_read_b128 v[32:35], v14 offset:32768
    v_mfma_f32_16x16x32_bf16 v[136:139], v[36:39], v[104:107], v[136:139]
    ds_read_b64_tr_b16 v[88:89], v168 offset:0
    ds_read_b64_tr_b16 v[90:91], v168 offset:1024
    v_mfma_f32_16x16x32_bf16 v[140:143], v[36:39], v[108:111], v[140:143]
    ds_read_b64_tr_b16 v[92:93], v169 offset:0
    ds_read_b64_tr_b16 v[94:95], v169 offset:1024
    v_mfma_f32_16x16x32_bf16 v[144:147], v[36:39], v[112:115], v[144:147]
    ds_read_b64_tr_b16 v[96:97], v170 offset:0
    ds_read_b64_tr_b16 v[98:99], v170 offset:1024
    v_mfma_f32_16x16x32_bf16 v[148:151], v[36:39], v[116:119], v[148:151]
    ds_read_b64_tr_b16 v[100:101], v171 offset:0
    ds_read_b64_tr_b16 v[102:103], v171 offset:1024
    s_waitcnt lgkmcnt(4)
    v_mfma_f32_16x16x32_bf16 v[120:123], v[32:35], v[88:91], v[120:123]
    ds_read_b64_tr_b16 v[104:105], v172 offset:0
    ds_read_b64_tr_b16 v[106:107], v172 offset:1024
    v_mfma_f32_16x16x32_bf16 v[124:127], v[32:35], v[92:95], v[124:127]
    ds_read_b64_tr_b16 v[108:109], v173 offset:0
    ds_read_b64_tr_b16 v[110:111], v173 offset:1024
    s_waitcnt lgkmcnt(4)
    v_mfma_f32_16x16x32_bf16 v[128:131], v[32:35], v[96:99], v[128:131]
    ds_read_b64_tr_b16 v[112:113], v174 offset:0
    ds_read_b64_tr_b16 v[114:115], v174 offset:1024
    v_mfma_f32_16x16x32_bf16 v[132:135], v[32:35], v[100:103], v[132:135]
    ds_read_b64_tr_b16 v[116:117], v175 offset:0
    ds_read_b64_tr_b16 v[118:119], v175 offset:1024
    ds_read_b128 v[36:39], v15 offset:32768
    s_waitcnt lgkmcnt(5)
    v_mfma_f32_16x16x32_bf16 v[136:139], v[32:35], v[104:107], v[136:139]
    ds_read_b64_tr_b16 v[88:89], v168 offset:8192
    ds_read_b64_tr_b16 v[90:91], v168 offset:9216
    v_mfma_f32_16x16x32_bf16 v[140:143], v[32:35], v[108:111], v[140:143]
    ds_read_b64_tr_b16 v[92:93], v169 offset:8192
    ds_read_b64_tr_b16 v[94:95], v169 offset:9216
    s_waitcnt lgkmcnt(4)
    v_mfma_f32_16x16x32_bf16 v[144:147], v[32:35], v[112:115], v[144:147]
    ds_read_b64_tr_b16 v[96:97], v170 offset:8192
    ds_read_b64_tr_b16 v[98:99], v170 offset:9216
    v_mfma_f32_16x16x32_bf16 v[148:151], v[32:35], v[116:119], v[148:151]
    ds_read_b64_tr_b16 v[100:101], v171 offset:8192
    ds_read_b64_tr_b16 v[102:103], v171 offset:9216
    s_waitcnt lgkmcnt(4)
    v_mfma_f32_16x16x32_bf16 v[120:123], v[36:39], v[88:91], v[120:123]
    ds_read_b64_tr_b16 v[104:105], v172 offset:8192
    ds_read_b64_tr_b16 v[106:107], v172 offset:9216
    v_mfma_f32_16x16x32_bf16 v[124:127], v[36:39], v[92:95], v[124:127]
    ds_read_b64_tr_b16 v[108:109], v173 offset:8192
    ds_read_b64_tr_b16 v[110:111], v173 offset:9216
    s_waitcnt lgkmcnt(4)
    v_mfma_f32_16x16x32_bf16 v[128:131], v[36:39], v[96:99], v[128:131]
    ds_read_b64_tr_b16 v[112:113], v174 offset:8192
    ds_read_b64_tr_b16 v[114:115], v174 offset:9216
    v_mfma_f32_16x16x32_bf16 v[132:135], v[36:39], v[100:103], v[132:135]
    ds_read_b64_tr_b16 v[116:117], v175 offset:8192
    ds_read_b64_tr_b16 v[118:119], v175 offset:9216
    s_waitcnt lgkmcnt(0)
    s_barrier
    ds_read_b128 v[32:35], v14 offset:40960
    v_mfma_f32_16x16x32_bf16 v[136:139], v[36:39], v[104:107], v[136:139]
    ds_read_b64_tr_b16 v[88:89], v168 offset:16384
    ds_read_b64_tr_b16 v[90:91], v168 offset:17408
    v_mfma_f32_16x16x32_bf16 v[140:143], v[36:39], v[108:111], v[140:143]
    ds_read_b64_tr_b16 v[92:93], v169 offset:16384
    ds_read_b64_tr_b16 v[94:95], v169 offset:17408
    v_mfma_f32_16x16x32_bf16 v[144:147], v[36:39], v[112:115], v[144:147]
    ds_read_b64_tr_b16 v[96:97], v170 offset:16384
    ds_read_b64_tr_b16 v[98:99], v170 offset:17408
    v_mfma_f32_16x16x32_bf16 v[148:151], v[36:39], v[116:119], v[148:151]
    ds_read_b64_tr_b16 v[100:101], v171 offset:16384
    ds_read_b64_tr_b16 v[102:103], v171 offset:17408
    s_waitcnt lgkmcnt(4)
    v_mfma_f32_16x16x32_bf16 v[120:123], v[32:35], v[88:91], v[120:123]
    ds_read_b64_tr_b16 v[104:105], v172 offset:16384
    ds_read_b64_tr_b16 v[106:107], v172 offset:17408
    v_mfma_f32_16x16x32_bf16 v[124:127], v[32:35], v[92:95], v[124:127]
    ds_read_b64_tr_b16 v[108:109], v173 offset:16384
    ds_read_b64_tr_b16 v[110:111], v173 offset:17408
    s_waitcnt lgkmcnt(4)
    v_mfma_f32_16x16x32_bf16 v[128:131], v[32:35], v[96:99], v[128:131]
    ds_read_b64_tr_b16 v[112:113], v174 offset:16384
    ds_read_b64_tr_b16 v[114:115], v174 offset:17408
    v_mfma_f32_16x16x32_bf16 v[132:135], v[32:35], v[100:103], v[132:135]
    ds_read_b64_tr_b16 v[116:117], v175 offset:16384
    ds_read_b64_tr_b16 v[118:119], v175 offset:17408
    ds_read_b128 v[36:39], v15 offset:40960
    s_waitcnt lgkmcnt(5)
    v_mfma_f32_16x16x32_bf16 v[136:139], v[32:35], v[104:107], v[136:139]
    ds_read_b64_tr_b16 v[88:89], v168 offset:24576
    ds_read_b64_tr_b16 v[90:91], v168 offset:25600
    v_mfma_f32_16x16x32_bf16 v[140:143], v[32:35], v[108:111], v[140:143]
    ds_read_b64_tr_b16 v[92:93], v169 offset:24576
    ds_read_b64_tr_b16 v[94:95], v169 offset:25600
    s_waitcnt lgkmcnt(4)
    v_mfma_f32_16x16x32_bf16 v[144:147], v[32:35], v[112:115], v[144:147]
    ds_read_b64_tr_b16 v[96:97], v170 offset:24576
    ds_read_b64_tr_b16 v[98:99], v170 offset:25600
    v_mfma_f32_16x16x32_bf16 v[148:151], v[32:35], v[116:119], v[148:151]
    ds_read_b64_tr_b16 v[100:101], v171 offset:24576
    ds_read_b64_tr_b16 v[102:103], v171 offset:25600
    s_waitcnt lgkmcnt(4)
    v_mfma_f32_16x16x32_bf16 v[120:123], v[36:39], v[88:91], v[120:123]
    ds_read_b64_tr_b16 v[104:105], v172 offset:24576
    ds_read_b64_tr_b16 v[106:107], v172 offset:25600
    v_mfma_f32_16x16x32_bf16 v[124:127], v[36:39], v[92:95], v[124:127]
    ds_read_b64_tr_b16 v[108:109], v173 offset:24576
    ds_read_b64_tr_b16 v[110:111], v173 offset:25600
    s_waitcnt lgkmcnt(4)
    v_mfma_f32_16x16x32_bf16 v[128:131], v[36:39], v[96:99], v[128:131]
    ds_read_b64_tr_b16 v[112:113], v174 offset:24576
    ds_read_b64_tr_b16 v[114:115], v174 offset:25600
    v_mfma_f32_16x16x32_bf16 v[132:135], v[36:39], v[100:103], v[132:135]
    ds_read_b64_tr_b16 v[116:117], v175 offset:24576
    ds_read_b64_tr_b16 v[118:119], v175 offset:25600
    s_waitcnt lgkmcnt(0)
    s_barrier
    ds_read_b128 v[32:35], v14 offset:49152
    v_mfma_f32_16x16x32_bf16 v[136:139], v[36:39], v[104:107], v[136:139]
    ds_read_b64_tr_b16 v[88:89], v168 offset:32768
    ds_read_b64_tr_b16 v[90:91], v168 offset:33792
    v_mfma_f32_16x16x32_bf16 v[140:143], v[36:39], v[108:111], v[140:143]
    ds_read_b64_tr_b16 v[92:93], v169 offset:32768
    ds_read_b64_tr_b16 v[94:95], v169 offset:33792
    v_mfma_f32_16x16x32_bf16 v[144:147], v[36:39], v[112:115], v[144:147]
    ds_read_b64_tr_b16 v[96:97], v170 offset:32768
    ds_read_b64_tr_b16 v[98:99], v170 offset:33792
    v_mfma_f32_16x16x32_bf16 v[148:151], v[36:39], v[116:119], v[148:151]
    ds_read_b64_tr_b16 v[100:101], v171 offset:32768
    ds_read_b64_tr_b16 v[102:103], v171 offset:33792
    s_waitcnt lgkmcnt(4)
    v_mfma_f32_16x16x32_bf16 v[120:123], v[32:35], v[88:91], v[120:123]
    ds_read_b64_tr_b16 v[104:105], v172 offset:32768
    ds_read_b64_tr_b16 v[106:107], v172 offset:33792
    v_mfma_f32_16x16x32_bf16 v[124:127], v[32:35], v[92:95], v[124:127]
    ds_read_b64_tr_b16 v[108:109], v173 offset:32768
    ds_read_b64_tr_b16 v[110:111], v173 offset:33792
    s_waitcnt lgkmcnt(4)
    v_mfma_f32_16x16x32_bf16 v[128:131], v[32:35], v[96:99], v[128:131]
    ds_read_b64_tr_b16 v[112:113], v174 offset:32768
    ds_read_b64_tr_b16 v[114:115], v174 offset:33792
    v_mfma_f32_16x16x32_bf16 v[132:135], v[32:35], v[100:103], v[132:135]
    ds_read_b64_tr_b16 v[116:117], v175 offset:32768
    ds_read_b64_tr_b16 v[118:119], v175 offset:33792
    ds_read_b128 v[36:39], v15 offset:49152
    s_waitcnt lgkmcnt(5)
    v_mfma_f32_16x16x32_bf16 v[136:139], v[32:35], v[104:107], v[136:139]
    ds_read_b64_tr_b16 v[88:89], v168 offset:40960
    ds_read_b64_tr_b16 v[90:91], v168 offset:41984
    v_mfma_f32_16x16x32_bf16 v[140:143], v[32:35], v[108:111], v[140:143]
    ds_read_b64_tr_b16 v[92:93], v169 offset:40960
    ds_read_b64_tr_b16 v[94:95], v169 offset:41984
    s_waitcnt lgkmcnt(4)
    v_mfma_f32_16x16x32_bf16 v[144:147], v[32:35], v[112:115], v[144:147]
    ds_read_b64_tr_b16 v[96:97], v170 offset:40960
    ds_read_b64_tr_b16 v[98:99], v170 offset:41984
    v_mfma_f32_16x16x32_bf16 v[148:151], v[32:35], v[116:119], v[148:151]
    ds_read_b64_tr_b16 v[100:101], v171 offset:40960
    ds_read_b64_tr_b16 v[102:103], v171 offset:41984
    s_waitcnt lgkmcnt(4)
    v_mfma_f32_16x16x32_bf16 v[120:123], v[36:39], v[88:91], v[120:123]
    ds_read_b64_tr_b16 v[104:105], v172 offset:40960
    ds_read_b64_tr_b16 v[106:107], v172 offset:41984
    v_mfma_f32_16x16x32_bf16 v[124:127], v[36:39], v[92:95], v[124:127]
    ds_read_b64_tr_b16 v[108:109], v173 offset:40960
    ds_read_b64_tr_b16 v[110:111], v173 offset:41984
    s_waitcnt lgkmcnt(4)
    v_mfma_f32_16x16x32_bf16 v[128:131], v[36:39], v[96:99], v[128:131]
    ds_read_b64_tr_b16 v[112:113], v174 offset:40960
    ds_read_b64_tr_b16 v[114:115], v174 offset:41984
    v_mfma_f32_16x16x32_bf16 v[132:135], v[36:39], v[100:103], v[132:135]
    ds_read_b64_tr_b16 v[116:117], v175 offset:40960
    ds_read_b64_tr_b16 v[118:119], v175 offset:41984
    s_waitcnt lgkmcnt(0)
    s_barrier
    v_mfma_f32_16x16x32_bf16 v[136:139], v[36:39], v[104:107], v[136:139]
    v_mfma_f32_16x16x32_bf16 v[140:143], v[36:39], v[108:111], v[140:143]
    v_mfma_f32_16x16x32_bf16 v[144:147], v[36:39], v[112:115], v[144:147]
    v_mfma_f32_16x16x32_bf16 v[148:151], v[36:39], v[116:119], v[148:151]
    v_pk_mul_f32 v[152:153], v[120:121], v[120:121]
    v_pk_mul_f32 v[154:155], v[122:123], v[122:123]
    v_pk_mul_f32 v[156:157], v[124:125], v[124:125]
    v_pk_mul_f32 v[158:159], v[126:127], v[126:127]
    v_pk_mul_f32 v[160:161], v[128:129], v[128:129]
    v_pk_mul_f32 v[162:163], v[130:131], v[130:131]
    v_pk_mul_f32 v[164:165], v[132:133], v[132:133]
    v_pk_mul_f32 v[166:167], v[134:135], v[134:135]
    v_pk_fma_f32 v[152:153], v[152:153], v[24:25], v[26:27]
    v_pk_fma_f32 v[154:155], v[154:155], v[24:25], v[26:27]
    v_pk_fma_f32 v[156:157], v[156:157], v[24:25], v[26:27]
    v_pk_fma_f32 v[158:159], v[158:159], v[24:25], v[26:27]
    v_pk_fma_f32 v[160:161], v[160:161], v[24:25], v[26:27]
    v_pk_fma_f32 v[162:163], v[162:163], v[24:25], v[26:27]
    v_pk_fma_f32 v[164:165], v[164:165], v[24:25], v[26:27]
    v_pk_fma_f32 v[166:167], v[166:167], v[24:25], v[26:27]
    v_pk_mul_f32 v[152:153], v[152:153], v[120:121]
    v_pk_mul_f32 v[154:155], v[154:155], v[122:123]
    v_pk_mul_f32 v[156:157], v[156:157], v[124:125]
    v_pk_mul_f32 v[158:159], v[158:159], v[126:127]
    v_pk_mul_f32 v[160:161], v[160:161], v[128:129]
    v_pk_mul_f32 v[162:163], v[162:163], v[130:131]
    v_pk_mul_f32 v[164:165], v[164:165], v[132:133]
    v_pk_mul_f32 v[166:167], v[166:167], v[134:135]
    v_exp_f32 v152, v152
    v_exp_f32 v153, v153
    v_exp_f32 v154, v154
    v_exp_f32 v155, v155
    v_exp_f32 v156, v156
    v_exp_f32 v157, v157
    v_exp_f32 v158, v158
    v_exp_f32 v159, v159
    v_exp_f32 v160, v160
    v_exp_f32 v161, v161
    v_exp_f32 v162, v162
    v_exp_f32 v163, v163
    v_exp_f32 v164, v164
    v_exp_f32 v165, v165
    v_exp_f32 v166, v166
    v_exp_f32 v167, v167
    v_pk_add_f32 v[152:153], v[152:153], v[30:31]
    v_pk_add_f32 v[154:155], v[154:155], v[30:31]
    v_pk_add_f32 v[156:157], v[156:157], v[30:31]
    v_pk_add_f32 v[158:159], v[158:159], v[30:31]
    v_pk_add_f32 v[160:161], v[160:161], v[30:31]
    v_pk_add_f32 v[162:163], v[162:163], v[30:31]
    v_pk_add_f32 v[164:165], v[164:165], v[30:31]
    v_pk_add_f32 v[166:167], v[166:167], v[30:31]
    v_rcp_f32 v152, v152
    v_rcp_f32 v153, v153
    v_rcp_f32 v154, v154
    v_rcp_f32 v155, v155
    v_rcp_f32 v156, v156
    v_rcp_f32 v157, v157
    v_rcp_f32 v158, v158
    v_rcp_f32 v159, v159
    v_rcp_f32 v160, v160
    v_rcp_f32 v161, v161
    v_rcp_f32 v162, v162
    v_rcp_f32 v163, v163
    v_rcp_f32 v164, v164
    v_rcp_f32 v165, v165
    v_rcp_f32 v166, v166
    v_rcp_f32 v167, v167
    v_pk_mul_f32 v[120:121], v[120:121], v[152:153]
    v_pk_mul_f32 v[122:123], v[122:123], v[154:155]
    v_pk_mul_f32 v[124:125], v[124:125], v[156:157]
    v_pk_mul_f32 v[126:127], v[126:127], v[158:159]
    v_pk_mul_f32 v[128:129], v[128:129], v[160:161]
    v_pk_mul_f32 v[130:131], v[130:131], v[162:163]
    v_pk_mul_f32 v[132:133], v[132:133], v[164:165]
    v_pk_mul_f32 v[134:135], v[134:135], v[166:167]
    v_pk_mul_f32 v[92:93], v[120:121], v[120:121]
    v_pk_mul_f32 v[94:95], v[122:123], v[122:123]
    v_pk_fma_f32 v[92:93], v[124:125], v[124:125], v[92:93]
    v_pk_add_f32 v[88:89], v[120:121], v[124:125]
    v_pk_fma_f32 v[94:95], v[126:127], v[126:127], v[94:95]
    v_pk_add_f32 v[90:91], v[122:123], v[126:127]
    v_pk_fma_f32 v[92:93], v[128:129], v[128:129], v[92:93]
    v_pk_add_f32 v[88:89], v[88:89], v[128:129]
    v_pk_fma_f32 v[94:95], v[130:131], v[130:131], v[94:95]
    v_pk_add_f32 v[90:91], v[90:91], v[130:131]
    v_pk_fma_f32 v[92:93], v[132:133], v[132:133], v[92:93]
    v_pk_add_f32 v[88:89], v[88:89], v[132:133]
    v_pk_fma_f32 v[94:95], v[134:135], v[134:135], v[94:95]
    v_pk_add_f32 v[90:91], v[90:91], v[134:135]
    v_pk_mul_f32 v[152:153], v[136:137], v[136:137]
    v_pk_mul_f32 v[154:155], v[138:139], v[138:139]
    v_pk_mul_f32 v[156:157], v[140:141], v[140:141]
    v_pk_mul_f32 v[158:159], v[142:143], v[142:143]
    v_pk_mul_f32 v[160:161], v[144:145], v[144:145]
    v_pk_mul_f32 v[162:163], v[146:147], v[146:147]
    v_pk_mul_f32 v[164:165], v[148:149], v[148:149]
    v_pk_mul_f32 v[166:167], v[150:151], v[150:151]
    v_pk_fma_f32 v[152:153], v[152:153], v[24:25], v[26:27]
    v_pk_fma_f32 v[154:155], v[154:155], v[24:25], v[26:27]
    v_pk_fma_f32 v[156:157], v[156:157], v[24:25], v[26:27]
    v_pk_fma_f32 v[158:159], v[158:159], v[24:25], v[26:27]
    v_pk_fma_f32 v[160:161], v[160:161], v[24:25], v[26:27]
    v_pk_fma_f32 v[162:163], v[162:163], v[24:25], v[26:27]
    v_pk_fma_f32 v[164:165], v[164:165], v[24:25], v[26:27]
    v_pk_fma_f32 v[166:167], v[166:167], v[24:25], v[26:27]
    v_pk_mul_f32 v[152:153], v[152:153], v[136:137]
    v_pk_mul_f32 v[154:155], v[154:155], v[138:139]
    v_pk_mul_f32 v[156:157], v[156:157], v[140:141]
    v_pk_mul_f32 v[158:159], v[158:159], v[142:143]
    v_pk_mul_f32 v[160:161], v[160:161], v[144:145]
    v_pk_mul_f32 v[162:163], v[162:163], v[146:147]
    v_pk_mul_f32 v[164:165], v[164:165], v[148:149]
    v_pk_mul_f32 v[166:167], v[166:167], v[150:151]
    v_exp_f32 v152, v152
    v_exp_f32 v153, v153
    v_exp_f32 v154, v154
    v_exp_f32 v155, v155
    v_exp_f32 v156, v156
    v_exp_f32 v157, v157
    v_exp_f32 v158, v158
    v_exp_f32 v159, v159
    v_exp_f32 v160, v160
    v_exp_f32 v161, v161
    v_exp_f32 v162, v162
    v_exp_f32 v163, v163
    v_exp_f32 v164, v164
    v_exp_f32 v165, v165
    v_exp_f32 v166, v166
    v_exp_f32 v167, v167
    v_pk_add_f32 v[152:153], v[152:153], v[30:31]
    v_pk_add_f32 v[154:155], v[154:155], v[30:31]
    v_pk_add_f32 v[156:157], v[156:157], v[30:31]
    v_pk_add_f32 v[158:159], v[158:159], v[30:31]
    v_pk_add_f32 v[160:161], v[160:161], v[30:31]
    v_pk_add_f32 v[162:163], v[162:163], v[30:31]
    v_pk_add_f32 v[164:165], v[164:165], v[30:31]
    v_pk_add_f32 v[166:167], v[166:167], v[30:31]
    v_rcp_f32 v152, v152
    v_rcp_f32 v153, v153
    v_rcp_f32 v154, v154
    v_rcp_f32 v155, v155
    v_rcp_f32 v156, v156
    v_rcp_f32 v157, v157
    v_rcp_f32 v158, v158
    v_rcp_f32 v159, v159
    v_rcp_f32 v160, v160
    v_rcp_f32 v161, v161
    v_rcp_f32 v162, v162
    v_rcp_f32 v163, v163
    v_rcp_f32 v164, v164
    v_rcp_f32 v165, v165
    v_rcp_f32 v166, v166
    v_rcp_f32 v167, v167
    v_pk_mul_f32 v[136:137], v[136:137], v[152:153]
    v_pk_mul_f32 v[138:139], v[138:139], v[154:155]
    v_pk_mul_f32 v[140:141], v[140:141], v[156:157]
    v_pk_mul_f32 v[142:143], v[142:143], v[158:159]
    v_pk_mul_f32 v[144:145], v[144:145], v[160:161]
    v_pk_mul_f32 v[146:147], v[146:147], v[162:163]
    v_pk_mul_f32 v[148:149], v[148:149], v[164:165]
    v_pk_mul_f32 v[150:151], v[150:151], v[166:167]
    v_pk_fma_f32 v[92:93], v[136:137], v[136:137], v[92:93]
    v_pk_add_f32 v[88:89], v[88:89], v[136:137]
    v_pk_fma_f32 v[94:95], v[138:139], v[138:139], v[94:95]
    v_pk_add_f32 v[90:91], v[90:91], v[138:139]
    v_pk_fma_f32 v[92:93], v[140:141], v[140:141], v[92:93]
    v_pk_add_f32 v[88:89], v[88:89], v[140:141]
    v_pk_fma_f32 v[94:95], v[142:143], v[142:143], v[94:95]
    v_pk_add_f32 v[90:91], v[90:91], v[142:143]
    v_pk_fma_f32 v[92:93], v[144:145], v[144:145], v[92:93]
    v_pk_add_f32 v[88:89], v[88:89], v[144:145]
    v_pk_fma_f32 v[94:95], v[146:147], v[146:147], v[94:95]
    v_pk_add_f32 v[90:91], v[90:91], v[146:147]
    v_pk_fma_f32 v[92:93], v[148:149], v[148:149], v[92:93]
    v_pk_add_f32 v[88:89], v[88:89], v[148:149]
    v_pk_fma_f32 v[94:95], v[150:151], v[150:151], v[94:95]
    v_pk_add_f32 v[90:91], v[90:91], v[150:151]
    v_add_f32_dpp v88, v88, v88 row_ror:8 row_mask:0xf bank_mask:0xf
    v_add_f32_dpp v89, v89, v89 row_ror:8 row_mask:0xf bank_mask:0xf
    v_add_f32_dpp v90, v90, v90 row_ror:8 row_mask:0xf bank_mask:0xf
    v_add_f32_dpp v91, v91, v91 row_ror:8 row_mask:0xf bank_mask:0xf
    v_add_f32_dpp v92, v92, v92 row_ror:8 row_mask:0xf bank_mask:0xf
    v_add_f32_dpp v93, v93, v93 row_ror:8 row_mask:0xf bank_mask:0xf
    v_add_f32_dpp v94, v94, v94 row_ror:8 row_mask:0xf bank_mask:0xf
    v_add_f32_dpp v95, v95, v95 row_ror:8 row_mask:0xf bank_mask:0xf
    v_add_f32_dpp v88, v88, v88 row_ror:4 row_mask:0xf bank_mask:0xf
    v_add_f32_dpp v89, v89, v89 row_ror:4 row_mask:0xf bank_mask:0xf
    v_add_f32_dpp v90, v90, v90 row_ror:4 row_mask:0xf bank_mask:0xf
    v_add_f32_dpp v91, v91, v91 row_ror:4 row_mask:0xf bank_mask:0xf
    v_add_f32_dpp v92, v92, v92 row_ror:4 row_mask:0xf bank_mask:0xf
    v_add_f32_dpp v93, v93, v93 row_ror:4 row_mask:0xf bank_mask:0xf
    v_add_f32_dpp v94, v94, v94 row_ror:4 row_mask:0xf bank_mask:0xf
    v_add_f32_dpp v95, v95, v95 row_ror:4 row_mask:0xf bank_mask:0xf
    v_add_f32_dpp v88, v88, v88 row_ror:2 row_mask:0xf bank_mask:0xf
    v_add_f32_dpp v89, v89, v89 row_ror:2 row_mask:0xf bank_mask:0xf
    v_add_f32_dpp v90, v90, v90 row_ror:2 row_mask:0xf bank_mask:0xf
    v_add_f32_dpp v91, v91, v91 row_ror:2 row_mask:0xf bank_mask:0xf
    v_add_f32_dpp v92, v92, v92 row_ror:2 row_mask:0xf bank_mask:0xf
    v_add_f32_dpp v93, v93, v93 row_ror:2 row_mask:0xf bank_mask:0xf
    v_add_f32_dpp v94, v94, v94 row_ror:2 row_mask:0xf bank_mask:0xf
    v_add_f32_dpp v95, v95, v95 row_ror:2 row_mask:0xf bank_mask:0xf
    v_add_f32_dpp v88, v88, v88 row_ror:1 row_mask:0xf bank_mask:0xf
    v_add_f32_dpp v89, v89, v89 row_ror:1 row_mask:0xf bank_mask:0xf
    v_add_f32_dpp v90, v90, v90 row_ror:1 row_mask:0xf bank_mask:0xf
    v_add_f32_dpp v91, v91, v91 row_ror:1 row_mask:0xf bank_mask:0xf
    v_add_f32_dpp v92, v92, v92 row_ror:1 row_mask:0xf bank_mask:0xf
    v_add_f32_dpp v93, v93, v93 row_ror:1 row_mask:0xf bank_mask:0xf
    v_add_f32_dpp v94, v94, v94 row_ror:1 row_mask:0xf bank_mask:0xf
    v_add_f32_dpp v95, v95, v95 row_ror:1 row_mask:0xf bank_mask:0xf
    v_cmp_eq_u32 vcc, 1, v19
    s_nop 1
    v_cndmask_b32 v152, v88, v89, vcc
    v_cndmask_b32 v154, v92, v93, vcc
    v_cmp_eq_u32 vcc, 2, v19
    s_nop 1
    v_cndmask_b32 v152, v152, v90, vcc
    v_cndmask_b32 v154, v154, v94, vcc
    v_cmp_eq_u32 vcc, 3, v19
    s_nop 1
    v_cndmask_b32 v152, v152, v91, vcc
    v_cndmask_b32 v154, v154, v95, vcc
    v_mov_b32 v153, v28
    v_mov_b32 v155, v28
    v_lshl_add_u32 v18, v9, 2, v19
    v_lshlrev_b32 v18, 4, v18
    s_lshl_b32 s24, s28, 2
    s_add_u32 s24, s24, s32
    s_lshl_b32 s24, s24, 11
    s_add_u32 s24, s24, 0xa90000
    s_lshl_b32 s35, s29, 8
    s_add_u32 s35, s35, s24
    s_mov_b32 exec_lo, 0x000f000f
    s_mov_b32 exec_hi, 0x000f000f
    buffer_store_dwordx4 v[152:155], v18, s[12:15], s35 offen sc1
    s_mov_b64 exec, -1
    v_min_u32 v18, 2, v9
    v_lshlrev_b32_e64 v18, 8, v18
    v_lshl_add_u32 v18, v8, 4, v18
    s_mov_b32 s44, s52
    s_mov_b32 s45, s53
    s_mov_b32 s46, 0xc4000
    s_mov_b32 s47, 0x20000
    v_and_b32 v3, 6, v21
    v_xor_b32 v3, v3, v0
    v_and_b32 v3, 7, v3
    v_lshlrev_b32 v3, 4, v3
    v_mul_u32_u24 v1, 896, v21
    v_add_u32_e64 v3, v3, v1
    s_lshl_b32 s35, s29, 7
    s_mul_i32 s30, s32, 7168
    s_add_u32 s30, s30, s35
    s_add_u32 s35, s30, 344064
    buffer_load_dwordx4 v[168:171], v3, s[44:47], s35 offen
    s_add_u32 s35, s30, 372736
    buffer_load_dwordx4 v[172:175], v3, s[44:47], s35 offen
    s_add_u32 s35, s30, 401408
    buffer_load_dwordx4 v[232:235], v3, s[44:47], s35 offen
    s_add_u32 s35, s30, 430080
    buffer_load_dwordx4 v[236:239], v3, s[44:47], s35 offen
    s_add_u32 s35, s30, 688128
    buffer_load_dwordx4 v[240:243], v3, s[44:47], s35 offen
    s_add_u32 s35, s30, 716800
    buffer_load_dwordx4 v[244:247], v3, s[44:47], s35 offen
    s_add_u32 s35, s30, 745472
    buffer_load_dwordx4 v[248:251], v3, s[44:47], s35 offen
    s_add_u32 s35, s30, 774144
    buffer_load_dwordx4 v[252:255], v3, s[44:47], s35 offen
    s_lshl_b32 s35, s32, 11
    v_subrev_u32 v14, s35, v14
    v_subrev_u32 v15, s35, v15
    s_mov_b32 s8, s48
    s_mov_b32 s9, s49
    s_mov_b32 s10, 0x800000
    s_mov_b32 s11, 0x20000
    v_lshl_add_u32 v10, v21, 12, v20
    v_add_u32 v11, 128, v10
    v_xor_b32 v12, 64, v10
    v_add_u32 v12, 0x8000, v12
    v_add_u32 v13, 128, v12
    s_lshl_b32 s42, s28, 2
    s_add_u32 s42, s42, s32
    s_lshl_b32 s42, s42, 16
    s_lshl_b32 s43, s32, 11
    s_mov_b32 s62, 1048576
L_wb1:
    ds_read_b32 v32, v5 offset:16
    s_waitcnt lgkmcnt(0)
    v_cmp_gt_u32 vcc, 1, v32
    s_cbranch_vccz L_wb1_ok
    s_sub_u32 s62, s62, 1
    s_cbranch_scc0 L_wb1
L_wb1_ok:
    ds_read_b64_tr_b16 v[64:65], v226 offset:49152
    s_nop 0
    ds_read_b64_tr_b16 v[66:67], v226 offset:49408
    ds_read_b64_tr_b16 v[68:69], v227 offset:49152
    ds_read_b64_tr_b16 v[70:71], v227 offset:49408
    ds_read_b128 v[72:75], v14 offset:0
    ds_read_b128 v[76:79], v14 offset:2048
    ds_read_b128 v[80:83], v14 offset:4096
    ds_read_b128 v[84:87], v14 offset:6144
    s_waitcnt lgkmcnt(0)
    s_nop 0
    v_mfma_f32_16x16x32_bf16 v[176:179], v[64:67], v[72:75], 0
    ds_read_b64_tr_b16 v[88:89], v226 offset:57344
    ds_read_b64_tr_b16 v[90:91], v226 offset:57600
    v_mfma_f32_16x16x32_bf16 v[180:183], v[64:67], v[76:79], 0
    ds_read_b64_tr_b16 v[92:93], v227 offset:57344
    ds_read_b64_tr_b16 v[94:95], v227 offset:57600
    v_mfma_f32_16x16x32_bf16 v[184:187], v[64:67], v[80:83], 0
    ds_read_b128 v[96:99], v15 offset:0
    ds_read_b128 v[100:103], v15 offset:2048
    v_mfma_f32_16x16x32_bf16 v[188:191], v[64:67], v[84:87], 0
    ds_read_b128 v[104:107], v15 offset:4096
    ds_read_b128 v[108:111], v15 offset:6144
    s_mul_i32 s35, s41, 114688
    s_add_u32 s35, s35, s38
    s_add_u32 m0, s40, 49152
    s_add_u32 s41, s41, 1
    buffer_load_dwordx4 v224, s[16:19], s35 offen lds
    s_add_u32 m0, s40, 50176
    s_cmp_eq_u32 s41, 14
    buffer_load_dwordx4 v225, s[16:19], s35 offen lds
    s_cselect_b32 s41, 0, s41
    v_mfma_f32_16x16x32_bf16 v[192:195], v[68:71], v[72:75], 0
    v_mfma_f32_16x16x32_bf16 v[196:199], v[68:71], v[76:79], 0
    v_mfma_f32_16x16x32_bf16 v[200:203], v[68:71], v[80:83], 0
    v_mfma_f32_16x16x32_bf16 v[204:207], v[68:71], v[84:87], 0
    s_waitcnt lgkmcnt(0)
    s_nop 0
    v_mfma_f32_16x16x32_bf16 v[176:179], v[88:91], v[96:99], v[176:179]
    ds_read_b64_tr_b16 v[64:65], v226 offset:0
    ds_read_b64_tr_b16 v[66:67], v226 offset:256
    v_mfma_f32_16x16x32_bf16 v[180:183], v[88:91], v[100:103], v[180:183]
    ds_read_b64_tr_b16 v[68:69], v227 offset:0
    ds_read_b64_tr_b16 v[70:71], v227 offset:256
    v_mfma_f32_16x16x32_bf16 v[184:187], v[88:91], v[104:107], v[184:187]
    ds_read_b128 v[72:75], v14 offset:8192
    ds_read_b128 v[76:79], v14 offset:10240
    v_mfma_f32_16x16x32_bf16 v[188:191], v[88:91], v[108:111], v[188:191]
    ds_read_b128 v[80:83], v14 offset:12288
    ds_read_b128 v[84:87], v14 offset:14336
    s_mul_i32 s35, s41, 114688
    s_add_u32 s35, s35, s38
    s_add_u32 m0, s40, 57344
    s_add_u32 s41, s41, 1
    buffer_load_dwordx4 v224, s[16:19], s35 offen lds
    s_add_u32 m0, s40, 58368
    s_cmp_eq_u32 s41, 14
    buffer_load_dwordx4 v225, s[16:19], s35 offen lds
    s_cselect_b32 s41, 0, s41
    v_mfma_f32_16x16x32_bf16 v[192:195], v[92:95], v[96:99], v[192:195]
    v_mfma_f32_16x16x32_bf16 v[196:199], v[92:95], v[100:103], v[196:199]
    v_mfma_f32_16x16x32_bf16 v[200:203], v[92:95], v[104:107], v[200:203]
    v_mfma_f32_16x16x32_bf16 v[204:207], v[92:95], v[108:111], v[204:207]
    s_waitcnt lgkmcnt(0)
    s_nop 0
    v_mfma_f32_16x16x32_bf16 v[176:179], v[64:67], v[72:75], v[176:179]
    ds_read_b64_tr_b16 v[88:89], v226 offset:8192
    ds_read_b64_tr_b16 v[90:91], v226 offset:8448
    v_mfma_f32_16x16x32_bf16 v[180:183], v[64:67], v[76:79], v[180:183]
    ds_read_b64_tr_b16 v[92:93], v227 offset:8192
    ds_read_b64_tr_b16 v[94:95], v227 offset:8448
    v_mfma_f32_16x16x32_bf16 v[184:187], v[64:67], v[80:83], v[184:187]
    ds_read_b128 v[96:99], v15 offset:8192
    ds_read_b128 v[100:103], v15 offset:10240
    v_mfma_f32_16x16x32_bf16 v[188:191], v[64:67], v[84:87], v[188:191]
    ds_read_b128 v[104:107], v15 offset:12288
    ds_read_b128 v[108:111], v15 offset:14336
    s_mul_i32 s35, s41, 114688
    s_add_u32 s35, s35, s38
    s_add_u32 m0, s40, 0
    s_add_u32 s41, s41, 1
    buffer_load_dwordx4 v224, s[16:19], s35 offen lds
    s_add_u32 m0, s40, 1024
    s_cmp_eq_u32 s41, 14
    buffer_load_dwordx4 v225, s[16:19], s35 offen lds
    s_cselect_b32 s41, 0, s41
    v_mfma_f32_16x16x32_bf16 v[192:195], v[68:71], v[72:75], v[192:195]
    v_mfma_f32_16x16x32_bf16 v[196:199], v[68:71], v[76:79], v[196:199]
    v_mfma_f32_16x16x32_bf16 v[200:203], v[68:71], v[80:83], v[200:203]
    v_mfma_f32_16x16x32_bf16 v[204:207], v[68:71], v[84:87], v[204:207]
    s_waitcnt lgkmcnt(0)
    v_mov_b32_e64 v23, 5
    ds_write_b32 v29, v23
    v_mfma_f32_16x16x32_bf16 v[176:179], v[88:91], v[96:99], v[176:179]
    ds_read_b64_tr_b16 v[64:65], v226 offset:16384
    ds_read_b64_tr_b16 v[66:67], v226 offset:16640
    v_mfma_f32_16x16x32_bf16 v[180:183], v[88:91], v[100:103], v[180:183]
    ds_read_b64_tr_b16 v[68:69], v227 offset:16384
    ds_read_b64_tr_b16 v[70:71], v227 offset:16640
    v_mfma_f32_16x16x32_bf16 v[184:187], v[88:91], v[104:107], v[184:187]
    ds_read_b128 v[72:75], v14 offset:16384
    ds_read_b128 v[76:79], v14 offset:18432
    v_mfma_f32_16x16x32_bf16 v[188:191], v[88:91], v[108:111], v[188:191]
    ds_read_b128 v[80:83], v14 offset:20480
    ds_read_b128 v[84:87], v14 offset:22528
    s_mul_i32 s35, s41, 114688
    s_add_u32 s35, s35, s38
    s_add_u32 m0, s40, 8192
    s_add_u32 s41, s41, 1
    buffer_load_dwordx4 v224, s[16:19], s35 offen lds
    s_add_u32 m0, s40, 9216
    s_cmp_eq_u32 s41, 14
    buffer_load_dwordx4 v225, s[16:19], s35 offen lds
    s_cselect_b32 s41, 0, s41
    v_mfma_f32_16x16x32_bf16 v[192:195], v[92:95], v[96:99], v[192:195]
    v_mfma_f32_16x16x32_bf16 v[196:199], v[92:95], v[100:103], v[196:199]
    v_mfma_f32_16x16x32_bf16 v[200:203], v[92:95], v[104:107], v[200:203]
    v_mfma_f32_16x16x32_bf16 v[204:207], v[92:95], v[108:111], v[204:207]
    s_waitcnt lgkmcnt(0)
    v_mfma_f32_16x16x32_bf16 v[176:179], v[64:67], v[72:75], v[176:179]
    ds_read_b64_tr_b16 v[88:89], v226 offset:24576
    ds_read_b64_tr_b16 v[90:91], v226 offset:24832
    s_nop 0
    v_mfma_f32_16x16x32_bf16 v[180:183], v[64:67], v[76:79], v[180:183]
    ds_read_b64_tr_b16 v[92:93], v227 offset:24576
    ds_read_b64_tr_b16 v[94:95], v227 offset:24832
    v_mfma_f32_16x16x32_bf16 v[184:187], v[64:67], v[80:83], v[184:187]
    ds_read_b128 v[96:99], v15 offset:16384
    ds_read_b128 v[100:103], v15 offset:18432
    v_mfma_f32_16x16x32_bf16 v[188:191], v[64:67], v[84:87], v[188:191]
    ds_read_b128 v[104:107], v15 offset:20480
    ds_read_b128 v[108:111], v15 offset:22528
    s_mul_i32 s35, s41, 114688
    s_add_u32 s35, s35, s38
    s_add_u32 m0, s40, 16384
    s_add_u32 s41, s41, 1
    buffer_load_dwordx4 v224, s[16:19], s35 offen lds
    s_add_u32 m0, s40, 17408
    s_cmp_eq_u32 s41, 14
    buffer_load_dwordx4 v225, s[16:19], s35 offen lds
    s_cselect_b32 s41, 0, s41
    v_mfma_f32_16x16x32_bf16 v[192:195], v[68:71], v[72:75], v[192:195]
    v_mfma_f32_16x16x32_bf16 v[196:199], v[68:71], v[76:79], v[196:199]
    v_mfma_f32_16x16x32_bf16 v[200:203], v[68:71], v[80:83], v[200:203]
    v_mfma_f32_16x16x32_bf16 v[204:207], v[68:71], v[84:87], v[204:207]
    s_waitcnt lgkmcnt(0)
    v_mfma_f32_16x16x32_bf16 v[176:179], v[88:91], v[96:99], v[176:179]
    ds_read_b64_tr_b16 v[64:65], v226 offset:32768
    ds_read_b64_tr_b16 v[66:67], v226 offset:33024
    s_nop 0
    v_mfma_f32_16x16x32_bf16 v[180:183], v[88:91], v[100:103], v[180:183]
    ds_read_b64_tr_b16 v[68:69], v227 offset:32768
    ds_read_b64_tr_b16 v[70:71], v227 offset:33024
    v_mfma_f32_16x16x32_bf16 v[184:187], v[88:91], v[104:107], v[184:187]
    ds_read_b128 v[72:75], v14 offset:24576
    ds_read_b128 v[76:79], v14 offset:26624
    v_mfma_f32_16x16x32_bf16 v[188:191], v[88:91], v[108:111], v[188:191]
    ds_read_b128 v[80:83], v14 offset:28672
    ds_read_b128 v[84:87], v14 offset:30720
    s_mul_i32 s35, s41, 114688
    s_add_u32 s35, s35, s38
    s_add_u32 m0, s40, 24576
    s_add_u32 s41, s41, 1
    buffer_load_dwordx4 v224, s[16:19], s35 offen lds
    s_add_u32 m0, s40, 25600
    s_cmp_eq_u32 s41, 14
    buffer_load_dwordx4 v225, s[16:19], s35 offen lds
    s_cselect_b32 s41, 0, s41
    v_mfma_f32_16x16x32_bf16 v[192:195], v[92:95], v[96:99], v[192:195]
    v_mfma_f32_16x16x32_bf16 v[196:199], v[92:95], v[100:103], v[196:199]
    v_mfma_f32_16x16x32_bf16 v[200:203], v[92:95], v[104:107], v[200:203]
    v_mfma_f32_16x16x32_bf16 v[204:207], v[92:95], v[108:111], v[204:207]
    buffer_load_dwordx4 v[32:35], v2, s[12:15], s24 offen sc1
    buffer_load_dwordx4 v[36:39], v18, s[12:15], s24 offen offset:1024 sc1
    ds_read_b128 v[56:59], v22
    s_waitcnt lgkmcnt(0)
    s_nop 0
    v_mfma_f32_16x16x32_bf16 v[176:179], v[64:67], v[72:75], v[176:179]
    ds_read_b64_tr_b16 v[88:89], v226 offset:40960
    ds_read_b64_tr_b16 v[90:91], v226 offset:41216
    v_min3_u32 v56, v56, v57, v58
    v_mfma_f32_16x16x32_bf16 v[180:183], v[64:67], v[76:79], v[180:183]
    ds_read_b64_tr_b16 v[92:93], v227 offset:40960
    ds_read_b64_tr_b16 v[94:95], v227 offset:41216
    v_min_u32_e64 v56, v56, v59
    v_mfma_f32_16x16x32_bf16 v[184:187], v[64:67], v[80:83], v[184:187]
    ds_read_b128 v[96:99], v15 offset:24576
    ds_read_b128 v[100:103], v15 offset:26624
    v_cmp_gt_u32 vcc, 5, v56
    v_mfma_f32_16x16x32_bf16 v[188:191], v[64:67], v[84:87], v[188:191]
    ds_read_b128 v[104:107], v15 offset:28672
    ds_read_b128 v[108:111], v15 offset:30720
    s_cbranch_vccnz L_z1_spin6
L_z1_ok6:
    s_add_u32 m0, s43, 65536
    s_nop 0
    buffer_load_dwordx4 v10, s[8:11], s42 offen lds
    v_mfma_f32_16x16x32_bf16 v[192:195], v[68:71], v[72:75], v[192:195]
    v_mfma_f32_16x16x32_bf16 v[196:199], v[68:71], v[76:79], v[196:199]
    v_mfma_f32_16x16x32_bf16 v[200:203], v[68:71], v[80:83], v[200:203]
    v_mfma_f32_16x16x32_bf16 v[204:207], v[68:71], v[84:87], v[204:207]
    s_add_u32 m0, s43, 66560
    s_nop 0
    buffer_load_dwordx4 v12, s[8:11], s42 offen lds
    s_waitcnt vmcnt(14)
    s_waitcnt lgkmcnt(0)
    v_mov_b32_e64 v23, 6
    ds_write_b32 v29, v23
    v_mfma_f32_16x16x32_bf16 v[176:179], v[88:91], v[96:99], v[176:179]
    ds_read_b64_tr_b16 v[64:65], v226 offset:49152
    ds_read_b64_tr_b16 v[66:67], v226 offset:49408
    v_mfma_f32_16x16x32_bf16 v[180:183], v[88:91], v[100:103], v[180:183]
    ds_read_b64_tr_b16 v[68:69], v227 offset:49152
    ds_read_b64_tr_b16 v[70:71], v227 offset:49408
    v_mfma_f32_16x16x32_bf16 v[184:187], v[88:91], v[104:107], v[184:187]
    ds_read_b128 v[72:75], v14 offset:32768
    ds_read_b128 v[76:79], v14 offset:34816
    v_mfma_f32_16x16x32_bf16 v[188:191], v[88:91], v[108:111], v[188:191]
    ds_read_b128 v[80:83], v14 offset:36864
    ds_read_b128 v[84:87], v14 offset:38912
    s_add_u32 m0, s43, 73728
    s_nop 0
    buffer_load_dwordx4 v11, s[8:11], s42 offen lds
    v_mfma_f32_16x16x32_bf16 v[192:195], v[92:95], v[96:99], v[192:195]
    v_mfma_f32_16x16x32_bf16 v[196:199], v[92:95], v[100:103], v[196:199]
    v_mfma_f32_16x16x32_bf16 v[200:203], v[92:95], v[104:107], v[200:203]
    v_mfma_f32_16x16x32_bf16 v[204:207], v[92:95], v[108:111], v[204:207]
    s_add_u32 m0, s43, 74752
    s_nop 0
    buffer_load_dwordx4 v13, s[8:11], s42 offen lds
    s_add_u32 s42, s42, 256
    s_mov_b32 s62, 65536
    s_waitcnt vmcnt(4)
    s_branch L_pst_chk
L_pst:
    buffer_load_dwordx4 v[32:35], v2, s[12:15], s24 offen sc1
    buffer_load_dwordx4 v[36:39], v18, s[12:15], s24 offen offset:1024 sc1
    s_waitcnt vmcnt(0)
L_pst_chk:
    v_cmp_ne_u32 vcc, v28, v33
    v_cmp_ne_u32 s[54:55], v28, v35
    s_or_b64 vcc, vcc, s[54:55]
    v_cmp_ne_u32 s[54:55], v28, v37
    s_or_b64 vcc, vcc, s[54:55]
    v_cmp_ne_u32 s[54:55], v28, v39
    s_or_b64 vcc, vcc, s[54:55]
    s_cbranch_vccz L_pst_ok
    s_sub_u32 s62, s62, 1
    s_cbranch_scc0 L_pst
L_pst_ok:
    v_cmp_gt_u32 vcc, 3, v9
    s_nop 1
    v_cndmask_b32 v36, 0, v36, vcc
    v_cndmask_b32 v38, 0, v38, vcc
    v_add_f32 v40, v32, v36
    v_add_f32 v41, v34, v38
    v_mov_b32 v42, v40
    v_mov_b32 v43, v41
    s_nop 0
    v_permlane16_swap_b32 v40, v42
    v_permlane16_swap_b32 v41, v43
    v_add_f32 v40, v40, v42
    v_add_f32 v41, v41, v43
    v_mov_b32 v42, v40
    v_mov_b32 v43, v41
    s_nop 0
    v_permlane32_swap_b32 v40, v42
    v_permlane32_swap_b32 v41, v43
    v_add_f32 v40, v40, v42
    v_add_f32 v41, v41, v43
    v_mul_f32 v40, 0x3a924925, v40
    v_mul_f32 v41, 0x3a924925, v41
    v_fma_f32 v41, -v40, v40, v41
    v_max_f32 v41, 0, v41
    v_add_f32 v41, 0x3727c5ac, v41
    v_rsq_f32 v41, v41
    v_lshlrev_b32 v53, 4, v9
    v_mul_f32 v40, v40, v41
    ds_bpermute_b32 v44, v53, v40 offset:0
    ds_bpermute_b32 v48, v53, v41 offset:0
    ds_bpermute_b32 v45, v53, v40 offset:4
    ds_bpermute_b32 v49, v53, v41 offset:4
    ds_bpermute_b32 v46, v53, v40 offset:8
    ds_bpermute_b32 v50, v53, v41 offset:8
    ds_bpermute_b32 v47, v53, v40 offset:12
    ds_bpermute_b32 v51, v53, v41 offset:12
    s_lshl_b32 s24, s29, 6
    s_lshl_b32 s25, s28, 1
    s_add_u32 s24, s24, s25
    s_lshr_b32 s25, s32, 1
    s_add_u32 s24, s24, s25
    s_lshl_b32 s24, s24, 13
    s_and_b32 s25, s32, 1
    s_lshl_b32 s25, s25, 9
    s_add_u32 s24, s24, s25
    s_add_u32 s25, s24, 4096
    v_lshrrev_b32 v53, 1, v9
    v_lshlrev_b32 v53, 8, v53
    v_lshl_add_u32 v53, v8, 4, v53
    v_and_b32 v54, 1, v9
    v_lshl_add_u32 v53, v54, 10, v53
    s_waitcnt lgkmcnt(0)
    v_pk_fma_f32 v[120:121], v[120:121], v[48:49], v[44:45] neg_lo:[0,0,1] neg_hi:[0,0,1]
    v_pk_fma_f32 v[122:123], v[122:123], v[50:51], v[46:47] neg_lo:[0,0,1] neg_hi:[0,0,1]
    s_nop 0
    v_pk_fma_f32 v[124:125], v[124:125], v[48:49], v[44:45] neg_lo:[0,0,1] neg_hi:[0,0,1]
    v_pk_fma_f32 v[126:127], v[126:127], v[50:51], v[46:47] neg_lo:[0,0,1] neg_hi:[0,0,1]
    v_pk_fma_f32 v[128:129], v[128:129], v[48:49], v[44:45] neg_lo:[0,0,1] neg_hi:[0,0,1]
    v_pk_fma_f32 v[130:131], v[130:131], v[50:51], v[46:47] neg_lo:[0,0,1] neg_hi:[0,0,1]
    v_pk_fma_f32 v[132:133], v[132:133], v[48:49], v[44:45] neg_lo:[0,0,1] neg_hi:[0,0,1]
    v_pk_fma_f32 v[134:135], v[134:135], v[50:51], v[46:47] neg_lo:[0,0,1] neg_hi:[0,0,1]
    v_cvt_pk_bf16_f32 v152, v120, v121
    v_cvt_pk_bf16_f32 v153, v122, v123
    v_cvt_pk_bf16_f32 v154, v124, v125
    v_cvt_pk_bf16_f32 v155, v126, v127
    v_cvt_pk_bf16_f32 v156, v128, v129
    v_cvt_pk_bf16_f32 v157, v130, v131
    v_cvt_pk_bf16_f32 v158, v132, v133
    v_cvt_pk_bf16_f32 v159, v134, v135
    v_permlane16_swap_b32 v152, v154
    v_permlane16_swap_b32 v153, v155
    v_permlane16_swap_b32 v156, v158
    v_permlane16_swap_b32 v157, v159
    buffer_store_dwordx4 v[152:155], v53, s[12:15], s24 offen offset:0 sc1
    buffer_store_dwordx4 v[156:159], v53, s[12:15], s24 offen offset:2048 sc1
    v_pk_fma_f32 v[136:137], v[136:137], v[48:49], v[44:45] neg_lo:[0,0,1] neg_hi:[0,0,1]
    v_pk_fma_f32 v[138:139], v[138:139], v[50:51], v[46:47] neg_lo:[0,0,1] neg_hi:[0,0,1]
    v_pk_fma_f32 v[140:141], v[140:141], v[48:49], v[44:45] neg_lo:[0,0,1] neg_hi:[0,0,1]
    v_pk_fma_f32 v[142:143], v[142:143], v[50:51], v[46:47] neg_lo:[0,0,1] neg_hi:[0,0,1]
    v_pk_fma_f32 v[144:145], v[144:145], v[48:49], v[44:45] neg_lo:[0,0,1] neg_hi:[0,0,1]
    v_pk_fma_f32 v[146:147], v[146:147], v[50:51], v[46:47] neg_lo:[0,0,1] neg_hi:[0,0,1]
    v_pk_fma_f32 v[148:149], v[148:149], v[48:49], v[44:45] neg_lo:[0,0,1] neg_hi:[0,0,1]
    v_pk_fma_f32 v[150:151], v[150:151], v[50:51], v[46:47] neg_lo:[0,0,1] neg_hi:[0,0,1]
    v_cvt_pk_bf16_f32 v160, v136, v137
    v_cvt_pk_bf16_f32 v161, v138, v139
    v_cvt_pk_bf16_f32 v162, v140, v141
    v_cvt_pk_bf16_f32 v163, v142, v143
    v_cvt_pk_bf16_f32 v164, v144, v145
    v_cvt_pk_bf16_f32 v165, v146, v147
    v_cvt_pk_bf16_f32 v166, v148, v149
    v_cvt_pk_bf16_f32 v167, v150, v151
    v_permlane16_swap_b32 v160, v162
    v_permlane16_swap_b32 v161, v163
    v_permlane16_swap_b32 v164, v166
    v_permlane16_swap_b32 v165, v167
    buffer_store_dwordx4 v[160:163], v53, s[12:15], s25 offen offset:0 sc1
    buffer_store_dwordx4 v[164:167], v53, s[12:15], s25 offen offset:2048 sc1
    ds_read_b128 v[56:59], v22
    s_waitcnt lgkmcnt(0)
    s_nop 0
    v_mfma_f32_16x16x32_bf16 v[176:179], v[64:67], v[72:75], v[176:179]
    ds_read_b64_tr_b16 v[88:89], v226 offset:57344
    ds_read_b64_tr_b16 v[90:91], v226 offset:57600
    v_min3_u32 v56, v56, v57, v58
    v_mfma_f32_16x16x32_bf16 v[180:183], v[64:67], v[76:79], v[180:183]
    ds_read_b64_tr_b16 v[92:93], v227 offset:57344
    ds_read_b64_tr_b16 v[94:95], v227 offset:57600
    v_min_u32_e64 v56, v56, v59
    v_mfma_f32_16x16x32_bf16 v[184:187], v[64:67], v[80:83], v[184:187]
    ds_read_b128 v[96:99], v15 offset:32768
    ds_read_b128 v[100:103], v15 offset:34816
    v_cmp_gt_u32 vcc, 6, v56
    v_mfma_f32_16x16x32_bf16 v[188:191], v[64:67], v[84:87], v[188:191]
    ds_read_b128 v[104:107], v15 offset:36864
    ds_read_b128 v[108:111], v15 offset:38912
    s_cbranch_vccnz L_z1_spin8
L_z1_ok8:
    s_add_u32 m0, s43, 81920
    s_nop 0
    buffer_load_dwordx4 v10, s[8:11], s42 offen lds
    v_mfma_f32_16x16x32_bf16 v[192:195], v[68:71], v[72:75], v[192:195]
    v_mfma_f32_16x16x32_bf16 v[196:199], v[68:71], v[76:79], v[196:199]
    v_mfma_f32_16x16x32_bf16 v[200:203], v[68:71], v[80:83], v[200:203]
    v_mfma_f32_16x16x32_bf16 v[204:207], v[68:71], v[84:87], v[204:207]
    s_add_u32 m0, s43, 82944
    s_nop 0
    buffer_load_dwordx4 v12, s[8:11], s42 offen lds
    s_waitcnt lgkmcnt(0)
    v_mov_b32 v23, 7
    ds_write_b32 v29, v23
    v_mfma_f32_16x16x32_bf16 v[176:179], v[88:91], v[96:99], v[176:179]
    ds_read_b64_tr_b16 v[64:65], v226 offset:0
    ds_read_b64_tr_b16 v[66:67], v226 offset:256
    v_mfma_f32_16x16x32_bf16 v[180:183], v[88:91], v[100:103], v[180:183]
    ds_read_b64_tr_b16 v[68:69], v227 offset:0
    ds_read_b64_tr_b16 v[70:71], v227 offset:256
    v_mfma_f32_16x16x32_bf16 v[184:187], v[88:91], v[104:107], v[184:187]
    ds_read_b128 v[72:75], v14 offset:40960
    ds_read_b128 v[76:79], v14 offset:43008
    v_mfma_f32_16x16x32_bf16 v[188:191], v[88:91], v[108:111], v[188:191]
    ds_read_b128 v[80:83], v14 offset:45056
    ds_read_b128 v[84:87], v14 offset:47104
    s_add_u32 m0, s43, 90112
    s_nop 0
    buffer_load_dwordx4 v11, s[8:11], s42 offen lds
    v_mfma_f32_16x16x32_bf16 v[192:195], v[92:95], v[96:99], v[192:195]
    v_mfma_f32_16x16x32_bf16 v[196:199], v[92:95], v[100:103], v[196:199]
    v_mfma_f32_16x16x32_bf16 v[200:203], v[92:95], v[104:107], v[200:203]
    v_mfma_f32_16x16x32_bf16 v[204:207], v[92:95], v[108:111], v[204:207]
    s_add_u32 m0, s43, 91136
    s_nop 0
    buffer_load_dwordx4 v13, s[8:11], s42 offen lds
    s_add_u32 s42, s42, 256
    s_waitcnt lgkmcnt(0)
    v_mfma_f32_16x16x32_bf16 v[176:179], v[64:67], v[72:75], v[176:179]
    ds_read_b64_tr_b16 v[88:89], v226 offset:8192
    ds_read_b64_tr_b16 v[90:91], v226 offset:8448
    s_nop 0
    v_mfma_f32_16x16x32_bf16 v[180:183], v[64:67], v[76:79], v[180:183]
    ds_read_b64_tr_b16 v[92:93], v227 offset:8192
    ds_read_b64_tr_b16 v[94:95], v227 offset:8448
    v_mfma_f32_16x16x32_bf16 v[184:187], v[64:67], v[80:83], v[184:187]
    ds_read_b128 v[96:99], v15 offset:40960
    ds_read_b128 v[100:103], v15 offset:43008
    v_mfma_f32_16x16x32_bf16 v[188:191], v[64:67], v[84:87], v[188:191]
    ds_read_b128 v[104:107], v15 offset:45056
    ds_read_b128 v[108:111], v15 offset:47104
    s_add_u32 m0, s43, 32768
    s_nop 0
    buffer_load_dwordx4 v10, s[8:11], s42 offen lds
    v_mfma_f32_16x16x32_bf16 v[192:195], v[68:71], v[72:75], v[192:195]
    v_mfma_f32_16x16x32_bf16 v[196:199], v[68:71], v[76:79], v[196:199]
    v_mfma_f32_16x16x32_bf16 v[200:203], v[68:71], v[80:83], v[200:203]
    v_mfma_f32_16x16x32_bf16 v[204:207], v[68:71], v[84:87], v[204:207]
    s_add_u32 m0, s43, 33792
    s_nop 0
    buffer_load_dwordx4 v12, s[8:11], s42 offen lds
    s_lshl_b32 s24, s29, 11
    s_add_u32 s24, s24, 0xad0000
    s_lshl_b32 s35, s28, 6
    s_lshl_b32 s25, s32, 2
    s_add_u32 s35, s35, s25
    v_mov_b32 v53, s35
    s_waitcnt vmcnt(6)
    s_mov_b64 exec, 1
    buffer_store_dword v28, v53, s[12:15], s24 offen sc1
    s_mov_b64 exec, -1
    s_waitcnt lgkmcnt(0)
    v_mov_b32 v23, 8
    ds_write_b32 v29, v23
    v_mfma_f32_16x16x32_bf16 v[176:179], v[88:91], v[96:99], v[176:179]
    ds_read_b64_tr_b16 v[64:65], v226 offset:16384
    ds_read_b64_tr_b16 v[66:67], v226 offset:16640
    v_mfma_f32_16x16x32_bf16 v[180:183], v[88:91], v[100:103], v[180:183]
    ds_read_b64_tr_b16 v[68:69], v227 offset:16384
    ds_read_b64_tr_b16 v[70:71], v227 offset:16640
    v_mfma_f32_16x16x32_bf16 v[184:187], v[88:91], v[104:107], v[184:187]
    ds_read_b128 v[72:75], v14 offset:49152
    ds_read_b128 v[76:79], v14 offset:51200
    v_mfma_f32_16x16x32_bf16 v[188:191], v[88:91], v[108:111], v[188:191]
    ds_read_b128 v[80:83], v14 offset:53248
    ds_read_b128 v[84:87], v14 offset:55296
    s_add_u32 m0, s43, 40960
    s_nop 0
    buffer_load_dwordx4 v11, s[8:11], s42 offen lds
    v_mfma_f32_16x16x32_bf16 v[192:195], v[92:95], v[96:99], v[192:195]
    v_mfma_f32_16x16x32_bf16 v[196:199], v[92:95], v[100:103], v[196:199]
    v_mfma_f32_16x16x32_bf16 v[200:203], v[92:95], v[104:107], v[200:203]
    v_mfma_f32_16x16x32_bf16 v[204:207], v[92:95], v[108:111], v[204:207]
    s_add_u32 m0, s43, 41984
    s_nop 0
    buffer_load_dwordx4 v13, s[8:11], s42 offen lds
    s_add_u32 s42, s42, 256
    ds_read_b128 v[56:59], v22
    s_waitcnt lgkmcnt(0)
    v_mfma_f32_16x16x32_bf16 v[176:179], v[64:67], v[72:75], v[176:179]
    ds_read_b64_tr_b16 v[88:89], v226 offset:24576
    ds_read_b64_tr_b16 v[90:91], v226 offset:24832
    v_min3_u32 v56, v56, v57, v58
    v_mfma_f32_16x16x32_bf16 v[180:183], v[64:67], v[76:79], v[180:183]
    ds_read_b64_tr_b16 v[92:93], v227 offset:24576
    ds_read_b64_tr_b16 v[94:95], v227 offset:24832
    v_min_u32 v56, v56, v59
    v_mfma_f32_16x16x32_bf16 v[184:187], v[64:67], v[80:83], v[184:187]
    ds_read_b128 v[96:99], v15 offset:49152
    ds_read_b128 v[100:103], v15 offset:51200
    v_cmp_gt_u32 vcc, 7, v56
    v_mfma_f32_16x16x32_bf16 v[188:191], v[64:67], v[84:87], v[188:191]
    ds_read_b128 v[104:107], v15 offset:53248
    ds_read_b128 v[108:111], v15 offset:55296
    s_cbranch_vccnz L_z1_spin12
L_z1_ok12:
    s_add_u32 m0, s43, 49152
    s_nop 0
    buffer_load_dwordx4 v10, s[8:11], s42 offen lds
    v_mfma_f32_16x16x32_bf16 v[192:195], v[68:71], v[72:75], v[192:195]
    v_mfma_f32_16x16x32_bf16 v[196:199], v[68:71], v[76:79], v[196:199]
    v_mfma_f32_16x16x32_bf16 v[200:203], v[68:71], v[80:83], v[200:203]
    v_mfma_f32_16x16x32_bf16 v[204:207], v[68:71], v[84:87], v[204:207]
    s_add_u32 m0, s43, 50176
    s_nop 0
    buffer_load_dwordx4 v12, s[8:11], s42 offen lds
    s_waitcnt lgkmcnt(0)
    v_mov_b32 v23, 9
    ds_write_b32 v29, v23
    v_mfma_f32_16x16x32_bf16 v[176:179], v[88:91], v[96:99], v[176:179]
    v_mfma_f32_16x16x32_bf16 v[180:183], v[88:91], v[100:103], v[180:183]
    v_mfma_f32_16x16x32_bf16 v[184:187], v[88:91], v[104:107], v[184:187]
    v_mfma_f32_16x16x32_bf16 v[188:191], v[88:91], v[108:111], v[188:191]
    s_add_u32 m0, s43, 57344
    s_nop 0
    buffer_load_dwordx4 v11, s[8:11], s42 offen lds
    v_mfma_f32_16x16x32_bf16 v[192:195], v[92:95], v[96:99], v[192:195]
    v_mfma_f32_16x16x32_bf16 v[196:199], v[92:95], v[100:103], v[196:199]
    v_mfma_f32_16x16x32_bf16 v[200:203], v[92:95], v[104:107], v[200:203]
    v_mfma_f32_16x16x32_bf16 v[204:207], v[92:95], v[108:111], v[204:207]
    s_add_u32 m0, s43, 58368
    s_nop 0
    buffer_load_dwordx4 v13, s[8:11], s42 offen lds
    s_add_u32 s42, s42, 256
    s_mov_b32 s62, 1048576
L_wa9:
    ds_read_b128 v[32:35], v22 offset:0
    s_waitcnt lgkmcnt(0)
    v_min3_u32 v32, v32, v33, v34
    v_min_u32 v32, v32, v35
    v_cmp_gt_u32 vcc, 9, v32
    s_cbranch_vccz L_wa9_ok
    s_sub_u32 s62, s62, 1
    s_cbranch_scc0 L_wa9
L_wa9_ok:
    v_lshlrev_b32_e64 v19, 6, v0
    s_add_u32 m0, s43, 98304
    s_nop 0
    buffer_load_dwordx4 v10, s[8:11], s42 offen lds
    v_pk_mul_f32 v[64:65], v[176:177], v[176:177]
    s_nop 0
    v_pk_mul_f32 v[66:67], v[178:179], v[178:179]
    v_pk_mul_f32 v[68:69], v[180:181], v[180:181]
    v_pk_mul_f32 v[70:71], v[182:183], v[182:183]
    v_pk_mul_f32 v[72:73], v[184:185], v[184:185]
    v_pk_mul_f32 v[74:75], v[186:187], v[186:187]
    v_pk_mul_f32 v[76:77], v[188:189], v[188:189]
    v_pk_mul_f32 v[78:79], v[190:191], v[190:191]
    s_add_u32 m0, s43, 99328
    s_nop 0
    buffer_load_dwordx4 v12, s[8:11], s42 offen lds
    v_pk_fma_f32 v[64:65], v[64:65], v[24:25], v[26:27]
    v_pk_fma_f32 v[66:67], v[66:67], v[24:25], v[26:27]
    s_nop 0
    v_pk_fma_f32 v[68:69], v[68:69], v[24:25], v[26:27]
    v_pk_fma_f32 v[70:71], v[70:71], v[24:25], v[26:27]
    v_pk_fma_f32 v[72:73], v[72:73], v[24:25], v[26:27]
    v_pk_fma_f32 v[74:75], v[74:75], v[24:25], v[26:27]
    v_pk_fma_f32 v[76:77], v[76:77], v[24:25], v[26:27]
    v_pk_fma_f32 v[78:79], v[78:79], v[24:25], v[26:27]
    s_add_u32 m0, s43, 106496
    s_nop 0
    s_nop 0
    buffer_load_dwordx4 v11, s[8:11], s42 offen lds
    v_pk_mul_f32 v[64:65], v[64:65], v[176:177]
    v_pk_mul_f32 v[66:67], v[66:67], v[178:179]
    v_pk_mul_f32 v[68:69], v[68:69], v[180:181]
    v_pk_mul_f32 v[70:71], v[70:71], v[182:183]
    v_pk_mul_f32 v[72:73], v[72:73], v[184:185]
    v_pk_mul_f32 v[74:75], v[74:75], v[186:187]
    v_pk_mul_f32 v[76:77], v[76:77], v[188:189]
    v_pk_mul_f32 v[78:79], v[78:79], v[190:191]
    s_add_u32 m0, s43, 107520
    s_nop 0
    buffer_load_dwordx4 v13, s[8:11], s42 offen lds
    s_add_u32 s42, s42, 256
    v_exp_f32 v64, v64
    v_exp_f32 v65, v65
    v_exp_f32 v66, v66
    v_exp_f32 v67, v67
    v_exp_f32 v68, v68
    v_exp_f32 v69, v69
    v_exp_f32 v70, v70
    v_exp_f32 v71, v71
    s_add_u32 m0, s43, 0
    s_nop 0
    buffer_load_dwordx4 v10, s[8:11], s42 offen lds
    v_exp_f32 v72, v72
    v_exp_f32 v73, v73
    v_exp_f32 v74, v74
    v_exp_f32 v75, v75
    v_exp_f32 v76, v76
    v_exp_f32 v77, v77
    v_exp_f32 v78, v78
    v_exp_f32 v79, v79
    s_add_u32 m0, s43, 1024
    s_nop 0
    buffer_load_dwordx4 v12, s[8:11], s42 offen lds
    v_pk_add_f32 v[64:65], v[64:65], v[30:31]
    v_pk_add_f32 v[66:67], v[66:67], v[30:31]
    v_pk_add_f32 v[68:69], v[68:69], v[30:31]
    v_pk_add_f32 v[70:71], v[70:71], v[30:31]
    v_pk_add_f32 v[72:73], v[72:73], v[30:31]
    v_pk_add_f32 v[74:75], v[74:75], v[30:31]
    v_pk_add_f32 v[76:77], v[76:77], v[30:31]
    v_pk_add_f32 v[78:79], v[78:79], v[30:31]
    s_add_u32 m0, s43, 8192
    s_nop 0
    buffer_load_dwordx4 v11, s[8:11], s42 offen lds
    v_rcp_f32 v64, v64
    v_rcp_f32 v65, v65
    v_rcp_f32 v66, v66
    v_rcp_f32 v67, v67
    v_rcp_f32 v68, v68
    v_rcp_f32 v69, v69
    v_rcp_f32 v70, v70
    v_rcp_f32_e64 v71, v71
    s_add_u32 m0, s43, 9216
    s_nop 0
    buffer_load_dwordx4 v13, s[8:11], s42 offen lds
    s_add_u32 s42, s42, 256
    v_rcp_f32 v72, v72
    v_rcp_f32 v73, v73
    v_rcp_f32 v74, v74
    v_rcp_f32 v75, v75
    v_rcp_f32 v76, v76
    v_rcp_f32 v77, v77
    v_rcp_f32 v78, v78
    v_rcp_f32_e64 v79, v79
    s_add_u32 m0, s43, 16384
    s_nop 0
    buffer_load_dwordx4 v10, s[8:11], s42 offen lds
    v_pk_mul_f32 v[176:177], v[176:177], v[64:65]
    s_nop 0
    v_pk_mul_f32 v[178:179], v[178:179], v[66:67]
    v_pk_mul_f32 v[180:181], v[180:181], v[68:69]
    v_pk_mul_f32 v[182:183], v[182:183], v[70:71]
    v_pk_mul_f32 v[184:185], v[184:185], v[72:73]
    v_pk_mul_f32 v[186:187], v[186:187], v[74:75]
    v_pk_mul_f32 v[188:189], v[188:189], v[76:77]
    v_pk_mul_f32 v[190:191], v[190:191], v[78:79]
    s_add_u32 m0, s43, 17408
    s_nop 0
    buffer_load_dwordx4 v12, s[8:11], s42 offen lds
    v_cvt_pk_bf16_f32 v208, v176, v177
    v_cvt_pk_bf16_f32 v209, v178, v179
    s_nop 0
    v_cvt_pk_bf16_f32 v212, v180, v181
    v_cvt_pk_bf16_f32 v213, v182, v183
    v_cvt_pk_bf16_f32 v216, v184, v185
    v_cvt_pk_bf16_f32 v217, v186, v187
    v_cvt_pk_bf16_f32 v220, v188, v189
    v_cvt_pk_bf16_f32 v221, v190, v191
    s_add_u32 m0, s43, 24576
    s_nop 0
    s_nop 0
    buffer_load_dwordx4 v11, s[8:11], s42 offen lds
    v_pk_mul_f32 v[64:65], v[192:193], v[192:193]
    v_pk_mul_f32 v[66:67], v[194:195], v[194:195]
    v_pk_mul_f32 v[68:69], v[196:197], v[196:197]
    v_pk_mul_f32 v[70:71], v[198:199], v[198:199]
    v_pk_mul_f32 v[72:73], v[200:201], v[200:201]
    v_pk_mul_f32 v[74:75], v[202:203], v[202:203]
    v_pk_mul_f32 v[76:77], v[204:205], v[204:205]
    v_pk_mul_f32 v[78:79], v[206:207], v[206:207]
    s_add_u32 m0, s43, 25600
    s_nop 0
    buffer_load_dwordx4 v13, s[8:11], s42 offen lds
    s_nop 0
    s_add_u32 s42, s42, 256
    v_pk_fma_f32 v[64:65], v[64:65], v[24:25], v[26:27]
    v_pk_fma_f32 v[66:67], v[66:67], v[24:25], v[26:27]
    v_pk_fma_f32 v[68:69], v[68:69], v[24:25], v[26:27]
    v_pk_fma_f32 v[70:71], v[70:71], v[24:25], v[26:27]
    v_pk_fma_f32 v[72:73], v[72:73], v[24:25], v[26:27]
    v_pk_fma_f32 v[74:75], v[74:75], v[24:25], v[26:27]
    v_pk_fma_f32 v[76:77], v[76:77], v[24:25], v[26:27]
    v_pk_fma_f32 v[78:79], v[78:79], v[24:25], v[26:27]
    v_pk_mul_f32 v[64:65], v[64:65], v[192:193]
    v_pk_mul_f32 v[66:67], v[66:67], v[194:195]
    v_pk_mul_f32 v[68:69], v[68:69], v[196:197]
    v_pk_mul_f32 v[70:71], v[70:71], v[198:199]
    v_pk_mul_f32 v[72:73], v[72:73], v[200:201]
    v_pk_mul_f32 v[74:75], v[74:75], v[202:203]
    v_pk_mul_f32 v[76:77], v[76:77], v[204:205]
    v_pk_mul_f32 v[78:79], v[78:79], v[206:207]
    v_exp_f32 v64, v64
    v_exp_f32 v65, v65
    v_exp_f32 v66, v66
    v_exp_f32 v67, v67
    v_exp_f32 v68, v68
    v_exp_f32 v69, v69
    v_exp_f32 v70, v70
    v_exp_f32 v71, v71
    v_exp_f32 v72, v72
    v_exp_f32 v73, v73
    v_exp_f32 v74, v74
    v_exp_f32 v75, v75
    v_exp_f32 v76, v76
    v_exp_f32 v77, v77
    v_exp_f32 v78, v78
    v_exp_f32 v79, v79
    v_pk_add_f32 v[64:65], v[64:65], v[30:31]
    v_pk_add_f32 v[66:67], v[66:67], v[30:31]
    v_pk_add_f32 v[68:69], v[68:69], v[30:31]
    v_pk_add_f32 v[70:71], v[70:71], v[30:31]
    v_pk_add_f32 v[72:73], v[72:73], v[30:31]
    v_pk_add_f32 v[74:75], v[74:75], v[30:31]
    v_pk_add_f32 v[76:77], v[76:77], v[30:31]
    v_pk_add_f32 v[78:79], v[78:79], v[30:31]
    v_rcp_f32 v64, v64
    v_rcp_f32 v65, v65
    v_rcp_f32 v66, v66
    v_rcp_f32 v67, v67
    v_rcp_f32 v68, v68
    v_rcp_f32 v69, v69
    v_rcp_f32 v70, v70
    v_rcp_f32 v71, v71
    v_rcp_f32 v72, v72
    v_rcp_f32 v73, v73
    v_rcp_f32 v74, v74
    v_rcp_f32 v75, v75
    v_rcp_f32 v76, v76
    v_rcp_f32 v77, v77
    v_rcp_f32 v78, v78
    v_rcp_f32 v79, v79
    v_pk_mul_f32 v[192:193], v[192:193], v[64:65]
    v_pk_mul_f32 v[194:195], v[194:195], v[66:67]
    v_pk_mul_f32 v[196:197], v[196:197], v[68:69]
    v_pk_mul_f32 v[198:199], v[198:199], v[70:71]
    v_pk_mul_f32 v[200:201], v[200:201], v[72:73]
    v_pk_mul_f32 v[202:203], v[202:203], v[74:75]
    v_pk_mul_f32 v[204:205], v[204:205], v[76:77]
    v_pk_mul_f32 v[206:207], v[206:207], v[78:79]
    v_cvt_pk_bf16_f32 v210, v192, v193
    v_cvt_pk_bf16_f32 v211, v194, v195
    v_cvt_pk_bf16_f32 v214, v196, v197
    v_cvt_pk_bf16_f32 v215, v198, v199
    v_cvt_pk_bf16_f32 v218, v200, v201
    v_cvt_pk_bf16_f32 v219, v202, v203
    v_cvt_pk_bf16_f32 v222, v204, v205
    v_cvt_pk_bf16_f32 v223, v206, v207
    s_mov_b32 s16, s12
    s_mov_b32 s17, s13
    s_mov_b32 s18, 0x380000
    s_mov_b32 s19, 0x20000
    v_lshlrev_b32 v19, 6, v0
    s_lshl_b32 s33, s29, 19
    s_lshl_b32 s35, s32, 11
    s_add_u32 s34, s33, s35
    v_lshrrev_b32 v20, 1, v8
    v_xor_b32 v20, v20, v9
    v_lshlrev_b32_e64 v20, 4, v20
    v_lshl_add_u32 v20, v8, 7, v20
    v_xor_b32_e64 v21, 64, v20
    v_add_u32 v17, 65536, v20
    v_add_u32 v18, 65536, v21
    v_add_u32 v14, 8192, v2
    v_add_u32 v15, 16384, v2
    v_add_u32 v16, 24576, v2
    s_mov_b32 s38, 0x71063254
    s_mov_b32 s39, 0x71063254
    s_mov_b32 s36, 10
    v_lshlrev_b32 v228, 16, v228
    v_mov_b32 v32, v228
    v_mov_b32 v33, v228
    v_mov_b32 v34, v228
    v_mov_b32 v35, v228
    v_mov_b32 v48, v228
    v_mov_b32 v49, v228
    v_mov_b32 v50, v228
    v_mov_b32 v51, v228
    v_lshlrev_b32 v229, 16, v229
    v_mov_b32 v36, v229
    v_mov_b32 v37, v229
    v_mov_b32 v38, v229
    v_mov_b32 v39, v229
    v_mov_b32 v52, v229
    v_mov_b32 v53, v229
    v_mov_b32 v54, v229
    v_mov_b32 v55, v229
    v_lshlrev_b32 v230, 16, v230
    v_mov_b32 v40, v230
    v_mov_b32 v41, v230
    v_mov_b32 v42, v230
    v_mov_b32 v43, v230
    v_mov_b32 v56, v230
    v_mov_b32 v57, v230
    v_mov_b32 v58, v230
    v_mov_b32 v59, v230
    v_lshlrev_b32 v231, 16, v231
    v_mov_b32 v44, v231
    v_mov_b32 v45, v231
    v_mov_b32 v46, v231
    v_mov_b32 v47, v231
    v_mov_b32 v60, v231
    v_mov_b32 v61, v231
    v_mov_b32 v62, v231
    v_mov_b32 v63, v231
    s_add_u32 s35, s30, 0
    buffer_load_dwordx4 v[176:179], v3, s[44:47], s35 offen
    s_add_u32 s35, s30, 28672
    buffer_load_dwordx4 v[180:183], v3, s[44:47], s35 offen
    s_add_u32 s35, s30, 57344
    buffer_load_dwordx4 v[184:187], v3, s[44:47], s35 offen
    s_add_u32 s35, s30, 86016
    buffer_load_dwordx4 v[188:191], v3, s[44:47], s35 offen
    s_add_u32 s35, s30, 114688
    buffer_load_dwordx4 v[192:195], v3, s[44:47], s35 offen
    s_add_u32 s35, s30, 143360
    buffer_load_dwordx4 v[196:199], v3, s[44:47], s35 offen
    s_add_u32 s35, s30, 172032
    buffer_load_dwordx4 v[200:203], v3, s[44:47], s35 offen
    s_add_u32 s35, s30, 200704
    buffer_load_dwordx4 v[204:207], v3, s[44:47], s35 offen
    s_cmp_lg_u32 s3, 0
    s_cbranch_scc1 L_nofz
    s_mov_b32 s62, 65536
    s_mov_b32 exec_hi, 0
L_pfz:
    buffer_load_dwordx4 v[160:163], v19, s[12:15], s24 offen sc1
    s_waitcnt vmcnt(0)
L_pfz_chk:
    v_cmp_ne_u32 vcc, v28, v160
    v_cmp_ne_u32 s[54:55], v28, v161
    s_or_b64 vcc, vcc, s[54:55]
    v_cmp_ne_u32 s[54:55], v28, v162
    s_or_b64 vcc, vcc, s[54:55]
    v_cmp_ne_u32 s[54:55], v28, v163
    s_or_b64 vcc, vcc, s[54:55]
    s_cbranch_vccz L_pfz_ok
    s_sleep 1
    s_sub_u32 s62, s62, 1
    s_cbranch_scc0 L_pfz
L_pfz_ok:
    s_mov_b64 exec, -1
L_nofz:
    s_waitcnt vmcnt(0)
    v_mov_b32_e64 v23, 10
    ds_write_b32 v29, v23
    s_mov_b32 s62, 1048576
L_wa10:
    ds_read_b128 v[160:163], v22 offset:0
    s_waitcnt lgkmcnt(0)
    v_min3_u32 v160, v160, v161, v162
    v_min_u32 v160, v160, v163
    v_cmp_gt_u32 vcc, 10, v160
    s_cbranch_vccz L_wa10_ok
    s_sub_u32 s62, s62, 1
    s_cbranch_scc0 L_wa10
L_wa10_ok:
    buffer_load_dwordx4 v[96:99], v2, s[16:19], s34 offen offset:0 sc1
    buffer_load_dwordx4 v[100:103], v2, s[16:19], s34 offen offset:1024 sc1
    buffer_load_dwordx4 v[104:107], v14, s[16:19], s34 offen offset:0 sc1
    buffer_load_dwordx4 v[108:111], v14, s[16:19], s34 offen offset:1024 sc1
    buffer_load_dwordx4 v[112:115], v15, s[16:19], s34 offen offset:0 sc1
    buffer_load_dwordx4 v[116:119], v15, s[16:19], s34 offen offset:1024 sc1
    buffer_load_dwordx4 v[120:123], v16, s[16:19], s34 offen offset:0 sc1
    buffer_load_dwordx4 v[124:127], v16, s[16:19], s34 offen offset:1024 sc1
    s_add_u32 s34, s34, 32768
    buffer_load_dwordx4 v[128:131], v2, s[16:19], s34 offen offset:0 sc1
    buffer_load_dwordx4 v[132:135], v2, s[16:19], s34 offen offset:1024 sc1
    buffer_load_dwordx4 v[136:139], v14, s[16:19], s34 offen offset:0 sc1
    buffer_load_dwordx4 v[140:143], v14, s[16:19], s34 offen offset:1024 sc1
    buffer_load_dwordx4 v[144:147], v15, s[16:19], s34 offen offset:0 sc1
    buffer_load_dwordx4 v[148:151], v15, s[16:19], s34 offen offset:1024 sc1
    buffer_load_dwordx4 v[152:155], v16, s[16:19], s34 offen offset:0 sc1
    buffer_load_dwordx4 v[156:159], v16, s[16:19], s34 offen offset:1024 sc1
    s_add_u32 s34, s34, 32768
    ds_read_b128 v[64:67], v17 offset:0
    ds_read_b128 v[68:71], v17 offset:2048
    ds_read_b128 v[72:75], v17 offset:4096
    ds_read_b128 v[76:79], v17 offset:6144
    s_lshl_b32 s43, s32, 11
    s_add_u32 s43, s43, 114688
    s_mov_b32 s40, 0x10632547
    s_mov_b32 s41, 7
    s_waitcnt vmcnt(14) lgkmcnt(0)
    v_mfma_f32_16x16x32_bf16 v[32:35], v[96:99], v[64:67], v[32:35]
    ds_read_b128 v[80:83], v18 offset:0
    v_mfma_f32_16x16x32_bf16 v[36:39], v[96:99], v[68:71], v[36:39]
    s_nop 0
    ds_read_b128 v[84:87], v18 offset:2048
    v_mfma_f32_16x16x32_bf16 v[40:43], v[96:99], v[72:75], v[40:43]
    ds_read_b128 v[88:91], v18 offset:4096
    v_mfma_f32_16x16x32_bf16 v[44:47], v[96:99], v[76:79], v[44:47]
    ds_read_b128 v[92:95], v18 offset:6144
    buffer_load_dwordx4 v[96:99], v2, s[16:19], s34 offen offset:0 sc1
    v_mfma_f32_16x16x32_bf16 v[48:51], v[100:103], v[64:67], v[48:51]
    ds_write_b32 v29, v23
    v_mfma_f32_16x16x32_bf16 v[52:55], v[100:103], v[68:71], v[52:55]
    v_mfma_f32_16x16x32_bf16 v[56:59], v[100:103], v[72:75], v[56:59]
    v_mfma_f32_16x16x32_bf16 v[60:63], v[100:103], v[76:79], v[60:63]
    buffer_load_dwordx4 v[100:103], v2, s[16:19], s34 offen offset:1024 sc1
    s_waitcnt vmcnt(14) lgkmcnt(0)
    v_mfma_f32_16x16x32_bf16 v[32:35], v[104:107], v[80:83], v[32:35]
    ds_read_b128 v[64:67], v17 offset:8192
    v_mfma_f32_16x16x32_bf16 v[36:39], v[104:107], v[84:87], v[36:39]
    s_nop 0
    ds_read_b128 v[68:71], v17 offset:10240
    v_mfma_f32_16x16x32_bf16 v[40:43], v[104:107], v[88:91], v[40:43]
    ds_read_b128 v[72:75], v17 offset:12288
    v_mfma_f32_16x16x32_bf16 v[44:47], v[104:107], v[92:95], v[44:47]
    ds_read_b128 v[76:79], v17 offset:14336
    buffer_load_dwordx4 v[104:107], v14, s[16:19], s34 offen offset:0 sc1
    v_mfma_f32_16x16x32_bf16 v[48:51], v[108:111], v[80:83], v[48:51]
    v_add_u32_e64 v23, 1, v23
    v_mfma_f32_16x16x32_bf16 v[52:55], v[108:111], v[84:87], v[52:55]
    s_lshr_b64 s[38:39], s[38:39], 4
    s_and_b32 s37, s38, 15
    s_lshl_b32 s37, s37, 14
    v_mfma_f32_16x16x32_bf16 v[56:59], v[108:111], v[88:91], v[56:59]
    v_mfma_f32_16x16x32_bf16 v[60:63], v[108:111], v[92:95], v[60:63]
    buffer_load_dwordx4 v[108:111], v14, s[16:19], s34 offen offset:1024 sc1
    s_waitcnt vmcnt(14) lgkmcnt(0)
    v_mfma_f32_16x16x32_bf16 v[32:35], v[112:115], v[64:67], v[32:35]
    ds_read_b128 v[80:83], v18 offset:8192
    v_mfma_f32_16x16x32_bf16 v[36:39], v[112:115], v[68:71], v[36:39]
    ds_read_b128 v[84:87], v18 offset:10240
    v_mfma_f32_16x16x32_bf16 v[40:43], v[112:115], v[72:75], v[40:43]
    ds_read_b128 v[88:91], v18 offset:12288
    v_mfma_f32_16x16x32_bf16 v[44:47], v[112:115], v[76:79], v[44:47]
    ds_read_b128 v[92:95], v18 offset:14336
    buffer_load_dwordx4 v[112:115], v15, s[16:19], s34 offen offset:0 sc1
    v_mfma_f32_16x16x32_bf16 v[48:51], v[116:119], v[64:67], v[48:51]
    ds_read_b128 v[160:163], v22
    ds_read_b128 v[164:167], v22 offset:16
    v_mfma_f32_16x16x32_bf16 v[52:55], v[116:119], v[68:71], v[52:55]
    v_add_u32_e64 v17, s37, v20
    v_mfma_f32_16x16x32_bf16 v[56:59], v[116:119], v[72:75], v[56:59]
    v_mfma_f32_16x16x32_bf16 v[60:63], v[116:119], v[76:79], v[60:63]
    buffer_load_dwordx4 v[116:119], v15, s[16:19], s34 offen offset:1024 sc1
    s_waitcnt vmcnt(14) lgkmcnt(0)
    s_nop 0
    v_mfma_f32_16x16x32_bf16 v[32:35], v[120:123], v[80:83], v[32:35]
    ds_read_b128 v[64:67], v17 offset:0
    v_mfma_f32_16x16x32_bf16 v[36:39], v[120:123], v[84:87], v[36:39]
    ds_read_b128 v[68:71], v17 offset:2048
    v_mfma_f32_16x16x32_bf16 v[40:43], v[120:123], v[88:91], v[40:43]
    ds_read_b128 v[72:75], v17 offset:4096
    v_mfma_f32_16x16x32_bf16 v[44:47], v[120:123], v[92:95], v[44:47]
    ds_read_b128 v[76:79], v17 offset:6144
    buffer_load_dwordx4 v[120:123], v16, s[16:19], s34 offen offset:0 sc1
    v_mfma_f32_16x16x32_bf16 v[48:51], v[124:127], v[80:83], v[48:51]
    v_min3_u32 v160, v160, v161, v162
    v_min3_u32 v164, v164, v165, v166
    v_add_u32 v18, s37, v21
    v_mfma_f32_16x16x32_bf16 v[52:55], v[124:127], v[84:87], v[52:55]
    v_min3_u32 v160, v160, v163, v167
    v_min_u32 v160, v160, v164
    v_mfma_f32_16x16x32_bf16 v[56:59], v[124:127], v[88:91], v[56:59]
    v_cmp_gt_u32 vcc, s36, v160
    v_mfma_f32_16x16x32_bf16 v[60:63], v[124:127], v[92:95], v[60:63]
    s_cbranch_vccnz L_pa0_spin3
L_pa0_ok3:
    buffer_load_dwordx4 v[124:127], v16, s[16:19], s34 offen offset:1024 sc1
    s_add_u32 s34, s34, 32768
    s_add_u32 s36, s36, 1
    s_waitcnt vmcnt(14) lgkmcnt(0)
    v_mfma_f32_16x16x32_bf16 v[32:35], v[128:131], v[64:67], v[32:35]
    ds_read_b128 v[80:83], v18 offset:0
    v_mfma_f32_16x16x32_bf16 v[36:39], v[128:131], v[68:71], v[36:39]
    ds_read_b128 v[84:87], v18 offset:2048
    v_mfma_f32_16x16x32_bf16 v[40:43], v[128:131], v[72:75], v[40:43]
    ds_read_b128 v[88:91], v18 offset:4096
    v_mfma_f32_16x16x32_bf16 v[44:47], v[128:131], v[76:79], v[44:47]
    ds_read_b128 v[92:95], v18 offset:6144
    buffer_load_dwordx4 v[128:131], v2, s[16:19], s34 offen offset:0 sc1
    v_mfma_f32_16x16x32_bf16 v[48:51], v[132:135], v[64:67], v[48:51]
    ds_write_b32 v29, v23
    v_mfma_f32_16x16x32_bf16 v[52:55], v[132:135], v[68:71], v[52:55]
    s_add_u32 m0, s43, 0
    v_mfma_f32_16x16x32_bf16 v[56:59], v[132:135], v[72:75], v[56:59]
    buffer_load_dwordx4 v10, s[8:11], s42 offen lds
    v_mfma_f32_16x16x32_bf16 v[60:63], v[132:135], v[76:79], v[60:63]
    buffer_load_dwordx4 v[132:135], v2, s[16:19], s34 offen offset:1024 sc1
    s_waitcnt vmcnt(14) lgkmcnt(0)
    v_mfma_f32_16x16x32_bf16 v[32:35], v[136:139], v[80:83], v[32:35]
    ds_read_b128 v[64:67], v17 offset:8192
    v_mfma_f32_16x16x32_bf16 v[36:39], v[136:139], v[84:87], v[36:39]
    ds_read_b128 v[68:71], v17 offset:10240
    v_mfma_f32_16x16x32_bf16 v[40:43], v[136:139], v[88:91], v[40:43]
    ds_read_b128 v[72:75], v17 offset:12288
    v_mfma_f32_16x16x32_bf16 v[44:47], v[136:139], v[92:95], v[44:47]
    ds_read_b128 v[76:79], v17 offset:14336
    buffer_load_dwordx4 v[136:139], v14, s[16:19], s34 offen offset:0 sc1
    v_mfma_f32_16x16x32_bf16 v[48:51], v[140:143], v[80:83], v[48:51]
    v_add_u32 v23, 1, v23
    v_mfma_f32_16x16x32_bf16 v[52:55], v[140:143], v[84:87], v[52:55]
    s_lshr_b64 s[38:39], s[38:39], 4
    s_and_b32 s37, s38, 15
    s_lshl_b32 s37, s37, 14
    s_add_u32 m0, s43, 1024
    v_mfma_f32_16x16x32_bf16 v[56:59], v[140:143], v[88:91], v[56:59]
    buffer_load_dwordx4 v12, s[8:11], s42 offen lds
    v_mfma_f32_16x16x32_bf16 v[60:63], v[140:143], v[92:95], v[60:63]
    buffer_load_dwordx4 v[140:143], v14, s[16:19], s34 offen offset:1024 sc1
    s_waitcnt vmcnt(14) lgkmcnt(0)
    v_mfma_f32_16x16x32_bf16 v[32:35], v[144:147], v[64:67], v[32:35]
    ds_read_b128 v[80:83], v18 offset:8192
    v_mfma_f32_16x16x32_bf16 v[36:39], v[144:147], v[68:71], v[36:39]
    s_nop 0
    ds_read_b128 v[84:87], v18 offset:10240
    v_mfma_f32_16x16x32_bf16 v[40:43], v[144:147], v[72:75], v[40:43]
    ds_read_b128 v[88:91], v18 offset:12288
    v_mfma_f32_16x16x32_bf16 v[44:47], v[144:147], v[76:79], v[44:47]
    ds_read_b128 v[92:95], v18 offset:14336
    buffer_load_dwordx4 v[144:147], v15, s[16:19], s34 offen offset:0 sc1
    v_mfma_f32_16x16x32_bf16 v[48:51], v[148:151], v[64:67], v[48:51]
    ds_read_b128 v[160:163], v22
    ds_read_b128 v[164:167], v22 offset:16
    v_mfma_f32_16x16x32_bf16 v[52:55], v[148:151], v[68:71], v[52:55]
    v_add_u32_e64 v17, s37, v20
    s_add_u32 m0, s43, 8192
    v_mfma_f32_16x16x32_bf16 v[56:59], v[148:151], v[72:75], v[56:59]
    buffer_load_dwordx4 v11, s[8:11], s42 offen lds
    v_mfma_f32_16x16x32_bf16 v[60:63], v[148:151], v[76:79], v[60:63]
    buffer_load_dwordx4 v[148:151], v15, s[16:19], s34 offen offset:1024 sc1
    s_waitcnt vmcnt(14) lgkmcnt(0)
    v_mfma_f32_16x16x32_bf16 v[32:35], v[152:155], v[80:83], v[32:35]
    ds_read_b128 v[64:67], v17 offset:0
    v_mfma_f32_16x16x32_bf16 v[36:39], v[152:155], v[84:87], v[36:39]
    s_nop 0
    ds_read_b128 v[68:71], v17 offset:2048
    v_mfma_f32_16x16x32_bf16 v[40:43], v[152:155], v[88:91], v[40:43]
    ds_read_b128 v[72:75], v17 offset:4096
    v_mfma_f32_16x16x32_bf16 v[44:47], v[152:155], v[92:95], v[44:47]
    ds_read_b128 v[76:79], v17 offset:6144
    buffer_load_dwordx4 v[152:155], v16, s[16:19], s34 offen offset:0 sc1
    v_mfma_f32_16x16x32_bf16 v[48:51], v[156:159], v[80:83], v[48:51]
    v_min3_u32 v160, v160, v161, v162
    v_min3_u32 v164, v164, v165, v166
    v_add_u32 v18, s37, v21
    v_mfma_f32_16x16x32_bf16 v[52:55], v[156:159], v[84:87], v[52:55]
    v_min3_u32 v160, v160, v163, v167
    v_min_u32 v160, v160, v164
    s_add_u32 m0, s43, 9216
    v_mfma_f32_16x16x32_bf16 v[56:59], v[156:159], v[88:91], v[56:59]
    buffer_load_dwordx4 v13, s[8:11], s42 offen lds
    v_cmp_gt_u32 vcc, s36, v160
    v_mfma_f32_16x16x32_bf16 v[60:63], v[156:159], v[92:95], v[60:63]
    s_add_u32 s42, s42, 256
    s_lshr_b64 s[40:41], s[40:41], 4
    s_and_b32 s43, s40, 15
    s_lshl_b32 s43, s43, 3
    s_add_u32 s43, s43, s32
    s_lshl_b32 s43, s43, 11
    s_cbranch_vccnz L_pa0_spin7
L_pa0_ok7:
    buffer_load_dwordx4 v[156:159], v16, s[16:19], s34 offen offset:1024 sc1
    s_add_u32 s34, s34, 32768
    s_add_u32 s36, s36, 1
L_p2a:
    s_waitcnt vmcnt(14) lgkmcnt(0)
    s_nop 0
    v_mfma_f32_16x16x32_bf16 v[32:35], v[96:99], v[64:67], v[32:35]
    ds_read_b128 v[80:83], v18 offset:0
    v_mfma_f32_16x16x32_bf16 v[36:39], v[96:99], v[68:71], v[36:39]
    ds_read_b128 v[84:87], v18 offset:2048
    v_mfma_f32_16x16x32_bf16 v[40:43], v[96:99], v[72:75], v[40:43]
    ds_read_b128 v[88:91], v18 offset:4096
    v_mfma_f32_16x16x32_bf16 v[44:47], v[96:99], v[76:79], v[44:47]
    ds_read_b128 v[92:95], v18 offset:6144
    buffer_load_dwordx4 v[96:99], v2, s[16:19], s34 offen offset:0 sc1
    v_mfma_f32_16x16x32_bf16 v[48:51], v[100:103], v[64:67], v[48:51]
    ds_write_b32 v29, v23
    v_mfma_f32_16x16x32_bf16 v[52:55], v[100:103], v[68:71], v[52:55]
    s_add_u32 m0, s43, 0
    v_mfma_f32_16x16x32_bf16 v[56:59], v[100:103], v[72:75], v[56:59]
    buffer_load_dwordx4 v10, s[8:11], s42 offen lds
    v_mfma_f32_16x16x32_bf16 v[60:63], v[100:103], v[76:79], v[60:63]
    buffer_load_dwordx4 v[100:103], v2, s[16:19], s34 offen offset:1024 sc1
    s_waitcnt vmcnt(14) lgkmcnt(0)
    v_mfma_f32_16x16x32_bf16 v[32:35], v[104:107], v[80:83], v[32:35]
    ds_read_b128 v[64:67], v17 offset:8192
    v_mfma_f32_16x16x32_bf16 v[36:39], v[104:107], v[84:87], v[36:39]
    ds_read_b128 v[68:71], v17 offset:10240
    v_mfma_f32_16x16x32_bf16 v[40:43], v[104:107], v[88:91], v[40:43]
    ds_read_b128 v[72:75], v17 offset:12288
    v_mfma_f32_16x16x32_bf16 v[44:47], v[104:107], v[92:95], v[44:47]
    ds_read_b128 v[76:79], v17 offset:14336
    buffer_load_dwordx4 v[104:107], v14, s[16:19], s34 offen offset:0 sc1
    v_mfma_f32_16x16x32_bf16 v[48:51], v[108:111], v[80:83], v[48:51]
    v_add_u32_e64 v23, 1, v23
    v_mfma_f32_16x16x32_bf16 v[52:55], v[108:111], v[84:87], v[52:55]
    s_lshr_b64 s[38:39], s[38:39], 4
    s_and_b32 s37, s38, 15
    s_lshl_b32 s37, s37, 14
    s_add_u32 m0, s43, 1024
    v_mfma_f32_16x16x32_bf16 v[56:59], v[108:111], v[88:91], v[56:59]
    buffer_load_dwordx4 v12, s[8:11], s42 offen lds
    v_mfma_f32_16x16x32_bf16 v[60:63], v[108:111], v[92:95], v[60:63]
    buffer_load_dwordx4 v[108:111], v14, s[16:19], s34 offen offset:1024 sc1
    s_waitcnt vmcnt(14) lgkmcnt(0)
    v_mfma_f32_16x16x32_bf16 v[32:35], v[112:115], v[64:67], v[32:35]
    ds_read_b128 v[80:83], v18 offset:8192
    v_mfma_f32_16x16x32_bf16 v[36:39], v[112:115], v[68:71], v[36:39]
    ds_read_b128 v[84:87], v18 offset:10240
    v_mfma_f32_16x16x32_bf16 v[40:43], v[112:115], v[72:75], v[40:43]
    ds_read_b128 v[88:91], v18 offset:12288
    v_mfma_f32_16x16x32_bf16 v[44:47], v[112:115], v[76:79], v[44:47]
    ds_read_b128 v[92:95], v18 offset:14336
    buffer_load_dwordx4 v[112:115], v15, s[16:19], s34 offen offset:0 sc1
    v_mfma_f32_16x16x32_bf16 v[48:51], v[116:119], v[64:67], v[48:51]
    ds_read_b128 v[160:163], v22
    ds_read_b128 v[164:167], v22 offset:16
    v_mfma_f32_16x16x32_bf16 v[52:55], v[116:119], v[68:71], v[52:55]
    v_add_u32_e64 v17, s37, v20
    s_add_u32 m0, s43, 8192
    v_mfma_f32_16x16x32_bf16 v[56:59], v[116:119], v[72:75], v[56:59]
    buffer_load_dwordx4 v11, s[8:11], s42 offen lds
    v_mfma_f32_16x16x32_bf16 v[60:63], v[116:119], v[76:79], v[60:63]
    buffer_load_dwordx4 v[116:119], v15, s[16:19], s34 offen offset:1024 sc1
    s_waitcnt vmcnt(14) lgkmcnt(0)
    s_nop 0
    v_mfma_f32_16x16x32_bf16 v[32:35], v[120:123], v[80:83], v[32:35]
    ds_read_b128 v[64:67], v17 offset:0
    v_mfma_f32_16x16x32_bf16 v[36:39], v[120:123], v[84:87], v[36:39]
    ds_read_b128 v[68:71], v17 offset:2048
    v_mfma_f32_16x16x32_bf16 v[40:43], v[120:123], v[88:91], v[40:43]
    ds_read_b128 v[72:75], v17 offset:4096
    v_mfma_f32_16x16x32_bf16 v[44:47], v[120:123], v[92:95], v[44:47]
    ds_read_b128 v[76:79], v17 offset:6144
    buffer_load_dwordx4 v[120:123], v16, s[16:19], s34 offen offset:0 sc1
    v_mfma_f32_16x16x32_bf16 v[48:51], v[124:127], v[80:83], v[48:51]
    v_min3_u32 v160, v160, v161, v162
    v_min3_u32 v164, v164, v165, v166
    v_add_u32 v18, s37, v21
    v_mfma_f32_16x16x32_bf16 v[52:55], v[124:127], v[84:87], v[52:55]
    v_min3_u32 v160, v160, v163, v167
    v_min_u32 v160, v160, v164
    s_add_u32 m0, s43, 9216
    v_mfma_f32_16x16x32_bf16 v[56:59], v[124:127], v[88:91], v[56:59]
    buffer_load_dwordx4 v13, s[8:11], s42 offen lds
    v_cmp_gt_u32 vcc, s36, v160
    v_mfma_f32_16x16x32_bf16 v[60:63], v[124:127], v[92:95], v[60:63]
    s_add_u32 s42, s42, 256
    s_lshr_b64 s[40:41], s[40:41], 4
    s_and_b32 s43, s40, 15
    s_lshl_b32 s43, s43, 3
    s_add_u32 s43, s43, s32
    s_lshl_b32 s43, s43, 11
    s_cbranch_vccnz L_pd_spin3
L_pd_ok3:
    buffer_load_dwordx4 v[124:127], v16, s[16:19], s34 offen offset:1024 sc1
    s_add_u32 s34, s34, 32768
    s_add_u32 s36, s36, 1
    s_waitcnt vmcnt(14) lgkmcnt(0)
    v_mfma_f32_16x16x32_bf16 v[32:35], v[128:131], v[64:67], v[32:35]
    s_nop 0
    ds_read_b128 v[80:83], v18 offset:0
    v_mfma_f32_16x16x32_bf16 v[36:39], v[128:131], v[68:71], v[36:39]
    ds_read_b128 v[84:87], v18 offset:2048
    v_mfma_f32_16x16x32_bf16 v[40:43], v[128:131], v[72:75], v[40:43]
    ds_read_b128 v[88:91], v18 offset:4096
    v_mfma_f32_16x16x32_bf16 v[44:47], v[128:131], v[76:79], v[44:47]
    ds_read_b128 v[92:95], v18 offset:6144
    buffer_load_dwordx4 v[128:131], v2, s[16:19], s34 offen offset:0 sc1
    v_mfma_f32_16x16x32_bf16 v[48:51], v[132:135], v[64:67], v[48:51]
    ds_write_b32 v29, v23
    v_mfma_f32_16x16x32_bf16 v[52:55], v[132:135], v[68:71], v[52:55]
    s_add_u32 m0, s43, 0
    v_mfma_f32_16x16x32_bf16 v[56:59], v[132:135], v[72:75], v[56:59]
    buffer_load_dwordx4 v10, s[8:11], s42 offen lds
    v_mfma_f32_16x16x32_bf16 v[60:63], v[132:135], v[76:79], v[60:63]
    buffer_load_dwordx4 v[132:135], v2, s[16:19], s34 offen offset:1024 sc1
    s_waitcnt vmcnt(14) lgkmcnt(0)
    v_mfma_f32_16x16x32_bf16 v[32:35], v[136:139], v[80:83], v[32:35]
    ds_read_b128 v[64:67], v17 offset:8192
    v_mfma_f32_16x16x32_bf16 v[36:39], v[136:139], v[84:87], v[36:39]
    ds_read_b128 v[68:71], v17 offset:10240
    v_mfma_f32_16x16x32_bf16 v[40:43], v[136:139], v[88:91], v[40:43]
    ds_read_b128 v[72:75], v17 offset:12288
    v_mfma_f32_16x16x32_bf16 v[44:47], v[136:139], v[92:95], v[44:47]
    ds_read_b128 v[76:79], v17 offset:14336
    buffer_load_dwordx4 v[136:139], v14, s[16:19], s34 offen offset:0 sc1
    v_mfma_f32_16x16x32_bf16 v[48:51], v[140:143], v[80:83], v[48:51]
    v_add_u32 v23, 1, v23
    v_mfma_f32_16x16x32_bf16 v[52:55], v[140:143], v[84:87], v[52:55]
    s_lshr_b64 s[38:39], s[38:39], 4
    s_and_b32 s37, s38, 15
    s_lshl_b32 s37, s37, 14
    s_add_u32 m0, s43, 1024
    v_mfma_f32_16x16x32_bf16 v[56:59], v[140:143], v[88:91], v[56:59]
    buffer_load_dwordx4 v12, s[8:11], s42 offen lds
    v_mfma_f32_16x16x32_bf16 v[60:63], v[140:143], v[92:95], v[60:63]
    buffer_load_dwordx4 v[140:143], v14, s[16:19], s34 offen offset:1024 sc1
    s_waitcnt vmcnt(14) lgkmcnt(0)
    v_mfma_f32_16x16x32_bf16 v[32:35], v[144:147], v[64:67], v[32:35]
    s_nop 0
    ds_read_b128 v[80:83], v18 offset:8192
    v_mfma_f32_16x16x32_bf16 v[36:39], v[144:147], v[68:71], v[36:39]
    ds_read_b128 v[84:87], v18 offset:10240
    v_mfma_f32_16x16x32_bf16 v[40:43], v[144:147], v[72:75], v[40:43]
    ds_read_b128 v[88:91], v18 offset:12288
    v_mfma_f32_16x16x32_bf16 v[44:47], v[144:147], v[76:79], v[44:47]
    ds_read_b128 v[92:95], v18 offset:14336
    buffer_load_dwordx4 v[144:147], v15, s[16:19], s34 offen offset:0 sc1
    v_mfma_f32_16x16x32_bf16 v[48:51], v[148:151], v[64:67], v[48:51]
    ds_read_b128 v[160:163], v22
    ds_read_b128 v[164:167], v22 offset:16
    v_mfma_f32_16x16x32_bf16 v[52:55], v[148:151], v[68:71], v[52:55]
    v_add_u32_e64 v17, s37, v20
    s_add_u32 m0, s43, 8192
    v_mfma_f32_16x16x32_bf16 v[56:59], v[148:151], v[72:75], v[56:59]
    buffer_load_dwordx4 v11, s[8:11], s42 offen lds
    v_mfma_f32_16x16x32_bf16 v[60:63], v[148:151], v[76:79], v[60:63]
    buffer_load_dwordx4 v[148:151], v15, s[16:19], s34 offen offset:1024 sc1
    s_waitcnt vmcnt(14) lgkmcnt(0)
    v_mfma_f32_16x16x32_bf16 v[32:35], v[152:155], v[80:83], v[32:35]
    s_nop 0
    ds_read_b128 v[64:67], v17 offset:0
    v_mfma_f32_16x16x32_bf16 v[36:39], v[152:155], v[84:87], v[36:39]
    ds_read_b128 v[68:71], v17 offset:2048
    v_mfma_f32_16x16x32_bf16 v[40:43], v[152:155], v[88:91], v[40:43]
    ds_read_b128 v[72:75], v17 offset:4096
    v_mfma_f32_16x16x32_bf16 v[44:47], v[152:155], v[92:95], v[44:47]
    ds_read_b128 v[76:79], v17 offset:6144
    buffer_load_dwordx4 v[152:155], v16, s[16:19], s34 offen offset:0 sc1
    v_mfma_f32_16x16x32_bf16 v[48:51], v[156:159], v[80:83], v[48:51]
    v_min3_u32 v160, v160, v161, v162
    v_min3_u32 v164, v164, v165, v166
    v_add_u32_e64 v18, s37, v21
    v_mfma_f32_16x16x32_bf16 v[52:55], v[156:159], v[84:87], v[52:55]
    v_min3_u32 v160, v160, v163, v167
    v_min_u32_e64 v160, v160, v164
    s_add_u32 m0, s43, 9216
    v_mfma_f32_16x16x32_bf16 v[56:59], v[156:159], v[88:91], v[56:59]
    buffer_load_dwordx4 v13, s[8:11], s42 offen lds
    v_cmp_gt_u32 vcc, s36, v160
    v_mfma_f32_16x16x32_bf16 v[60:63], v[156:159], v[92:95], v[60:63]
    s_add_u32 s42, s42, 256
    s_lshr_b64 s[40:41], s[40:41], 4
    s_and_b32 s43, s40, 15
    s_lshl_b32 s43, s43, 3
    s_add_u32 s43, s43, s32
    s_lshl_b32 s43, s43, 11
    s_cbranch_vccnz L_pd_spin7
L_pd_ok7:
    buffer_load_dwordx4 v[156:159], v16, s[16:19], s34 offen offset:1024 sc1
    s_add_u32 s34, s34, 32768
    s_add_u32 s36, s36, 1
    s_cmp_lt_u32 s36, 20
    s_cbranch_scc1 L_p2a
L_p2:
    s_waitcnt vmcnt(14) lgkmcnt(0)
    s_nop 0
    v_mfma_f32_16x16x32_bf16 v[32:35], v[96:99], v[64:67], v[32:35]
    ds_read_b128 v[80:83], v18 offset:0
    v_mfma_f32_16x16x32_bf16 v[36:39], v[96:99], v[68:71], v[36:39]
    ds_read_b128 v[84:87], v18 offset:2048
    v_mfma_f32_16x16x32_bf16 v[40:43], v[96:99], v[72:75], v[40:43]
    ds_read_b128 v[88:91], v18 offset:4096
    v_mfma_f32_16x16x32_bf16 v[44:47], v[96:99], v[76:79], v[44:47]
    ds_read_b128 v[92:95], v18 offset:6144
    buffer_load_dwordx4 v[96:99], v2, s[16:19], s34 offen offset:0 sc1
    v_mfma_f32_16x16x32_bf16 v[48:51], v[100:103], v[64:67], v[48:51]
    ds_write_b32 v29, v23
    v_mfma_f32_16x16x32_bf16 v[52:55], v[100:103], v[68:71], v[52:55]
    v_mfma_f32_16x16x32_bf16 v[56:59], v[100:103], v[72:75], v[56:59]
    v_mfma_f32_16x16x32_bf16 v[60:63], v[100:103], v[76:79], v[60:63]
    buffer_load_dwordx4 v[100:103], v2, s[16:19], s34 offen offset:1024 sc1
    s_waitcnt vmcnt(14) lgkmcnt(0)
    s_nop 0
    v_mfma_f32_16x16x32_bf16 v[32:35], v[104:107], v[80:83], v[32:35]
    ds_read_b128 v[64:67], v17 offset:8192
    v_mfma_f32_16x16x32_bf16 v[36:39], v[104:107], v[84:87], v[36:39]
    ds_read_b128 v[68:71], v17 offset:10240
    v_mfma_f32_16x16x32_bf16 v[40:43], v[104:107], v[88:91], v[40:43]
    ds_read_b128 v[72:75], v17 offset:12288
    v_mfma_f32_16x16x32_bf16 v[44:47], v[104:107], v[92:95], v[44:47]
    ds_read_b128 v[76:79], v17 offset:14336
    buffer_load_dwordx4 v[104:107], v14, s[16:19], s34 offen offset:0 sc1
    v_mfma_f32_16x16x32_bf16 v[48:51], v[108:111], v[80:83], v[48:51]
    v_add_u32 v23, 1, v23
    v_mfma_f32_16x16x32_bf16 v[52:55], v[108:111], v[84:87], v[52:55]
    s_lshr_b64 s[38:39], s[38:39], 4
    s_and_b32 s37, s38, 15
    s_lshl_b32 s37, s37, 14
    v_mfma_f32_16x16x32_bf16 v[56:59], v[108:111], v[88:91], v[56:59]
    v_mfma_f32_16x16x32_bf16 v[60:63], v[108:111], v[92:95], v[60:63]
    buffer_load_dwordx4 v[108:111], v14, s[16:19], s34 offen offset:1024 sc1
    s_waitcnt vmcnt(14) lgkmcnt(0)
    v_mfma_f32_16x16x32_bf16 v[32:35], v[112:115], v[64:67], v[32:35]
    ds_read_b128 v[80:83], v18 offset:8192
    v_mfma_f32_16x16x32_bf16 v[36:39], v[112:115], v[68:71], v[36:39]
    s_nop 0
    ds_read_b128 v[84:87], v18 offset:10240
    v_mfma_f32_16x16x32_bf16 v[40:43], v[112:115], v[72:75], v[40:43]
    ds_read_b128 v[88:91], v18 offset:12288
    v_mfma_f32_16x16x32_bf16 v[44:47], v[112:115], v[76:79], v[44:47]
    ds_read_b128 v[92:95], v18 offset:14336
    buffer_load_dwordx4 v[112:115], v15, s[16:19], s34 offen offset:0 sc1
    v_mfma_f32_16x16x32_bf16 v[48:51], v[116:119], v[64:67], v[48:51]
    ds_read_b128 v[160:163], v22
    ds_read_b128 v[164:167], v22 offset:16
    v_mfma_f32_16x16x32_bf16 v[52:55], v[116:119], v[68:71], v[52:55]
    v_add_u32_e64 v17, s37, v20
    v_mfma_f32_16x16x32_bf16 v[56:59], v[116:119], v[72:75], v[56:59]
    v_mfma_f32_16x16x32_bf16 v[60:63], v[116:119], v[76:79], v[60:63]
    buffer_load_dwordx4 v[116:119], v15, s[16:19], s34 offen offset:1024 sc1
    s_waitcnt vmcnt(14) lgkmcnt(0)
    v_mfma_f32_16x16x32_bf16 v[32:35], v[120:123], v[80:83], v[32:35]
    s_nop 0
    ds_read_b128 v[64:67], v17 offset:0
    v_mfma_f32_16x16x32_bf16 v[36:39], v[120:123], v[84:87], v[36:39]
    ds_read_b128 v[68:71], v17 offset:2048
    v_mfma_f32_16x16x32_bf16 v[40:43], v[120:123], v[88:91], v[40:43]
    ds_read_b128 v[72:75], v17 offset:4096
    v_mfma_f32_16x16x32_bf16 v[44:47], v[120:123], v[92:95], v[44:47]
    ds_read_b128 v[76:79], v17 offset:6144
    buffer_load_dwordx4 v[120:123], v16, s[16:19], s34 offen offset:0 sc1
    v_mfma_f32_16x16x32_bf16 v[48:51], v[124:127], v[80:83], v[48:51]
    v_min3_u32 v160, v160, v161, v162
    v_min3_u32 v164, v164, v165, v166
    v_add_u32_e64 v18, s37, v21
    v_mfma_f32_16x16x32_bf16 v[52:55], v[124:127], v[84:87], v[52:55]
    v_min3_u32 v160, v160, v163, v167
    v_min_u32 v160, v160, v164
    v_mfma_f32_16x16x32_bf16 v[56:59], v[124:127], v[88:91], v[56:59]
    v_cmp_gt_u32 vcc, s36, v160
    v_mfma_f32_16x16x32_bf16 v[60:63], v[124:127], v[92:95], v[60:63]
    s_cbranch_vccnz L_pb_spin3
L_pb_ok3:
    buffer_load_dwordx4 v[124:127], v16, s[16:19], s34 offen offset:1024 sc1
    s_add_u32 s34, s34, 32768
    s_add_u32 s36, s36, 1
    s_waitcnt vmcnt(14) lgkmcnt(0)
    v_mfma_f32_16x16x32_bf16 v[32:35], v[128:131], v[64:67], v[32:35]
    ds_read_b128 v[80:83], v18 offset:0
    v_mfma_f32_16x16x32_bf16 v[36:39], v[128:131], v[68:71], v[36:39]
    s_nop 0
    ds_read_b128 v[84:87], v18 offset:2048
    v_mfma_f32_16x16x32_bf16 v[40:43], v[128:131], v[72:75], v[40:43]
    ds_read_b128 v[88:91], v18 offset:4096
    v_mfma_f32_16x16x32_bf16 v[44:47], v[128:131], v[76:79], v[44:47]
    ds_read_b128 v[92:95], v18 offset:6144
    buffer_load_dwordx4 v[128:131], v2, s[16:19], s34 offen offset:0 sc1
    v_mfma_f32_16x16x32_bf16 v[48:51], v[132:135], v[64:67], v[48:51]
    ds_write_b32 v29, v23
    v_mfma_f32_16x16x32_bf16 v[52:55], v[132:135], v[68:71], v[52:55]
    v_mfma_f32_16x16x32_bf16 v[56:59], v[132:135], v[72:75], v[56:59]
    v_mfma_f32_16x16x32_bf16 v[60:63], v[132:135], v[76:79], v[60:63]
    buffer_load_dwordx4 v[132:135], v2, s[16:19], s34 offen offset:1024 sc1
    s_waitcnt vmcnt(14) lgkmcnt(0)
    v_mfma_f32_16x16x32_bf16 v[32:35], v[136:139], v[80:83], v[32:35]
    ds_read_b128 v[64:67], v17 offset:8192
    v_mfma_f32_16x16x32_bf16 v[36:39], v[136:139], v[84:87], v[36:39]
    s_nop 0
    ds_read_b128 v[68:71], v17 offset:10240
    v_mfma_f32_16x16x32_bf16 v[40:43], v[136:139], v[88:91], v[40:43]
    ds_read_b128 v[72:75], v17 offset:12288
    v_mfma_f32_16x16x32_bf16 v[44:47], v[136:139], v[92:95], v[44:47]
    ds_read_b128 v[76:79], v17 offset:14336
    buffer_load_dwordx4 v[136:139], v14, s[16:19], s34 offen offset:0 sc1
    v_mfma_f32_16x16x32_bf16 v[48:51], v[140:143], v[80:83], v[48:51]
    v_add_u32_e64 v23, 1, v23
    v_mfma_f32_16x16x32_bf16 v[52:55], v[140:143], v[84:87], v[52:55]
    s_lshr_b64 s[38:39], s[38:39], 4
    s_and_b32 s37, s38, 15
    s_lshl_b32 s37, s37, 14
    v_mfma_f32_16x16x32_bf16 v[56:59], v[140:143], v[88:91], v[56:59]
    v_mfma_f32_16x16x32_bf16 v[60:63], v[140:143], v[92:95], v[60:63]
    buffer_load_dwordx4 v[140:143], v14, s[16:19], s34 offen offset:1024 sc1
    s_waitcnt vmcnt(14) lgkmcnt(0)
    v_mfma_f32_16x16x32_bf16 v[32:35], v[144:147], v[64:67], v[32:35]
    ds_read_b128 v[80:83], v18 offset:8192
    v_mfma_f32_16x16x32_bf16 v[36:39], v[144:147], v[68:71], v[36:39]
    ds_read_b128 v[84:87], v18 offset:10240
    v_mfma_f32_16x16x32_bf16 v[40:43], v[144:147], v[72:75], v[40:43]
    ds_read_b128 v[88:91], v18 offset:12288
    v_mfma_f32_16x16x32_bf16 v[44:47], v[144:147], v[76:79], v[44:47]
    ds_read_b128 v[92:95], v18 offset:14336
    buffer_load_dwordx4 v[144:147], v15, s[16:19], s34 offen offset:0 sc1
    v_mfma_f32_16x16x32_bf16 v[48:51], v[148:151], v[64:67], v[48:51]
    ds_read_b128 v[160:163], v22
    ds_read_b128 v[164:167], v22 offset:16
    v_mfma_f32_16x16x32_bf16 v[52:55], v[148:151], v[68:71], v[52:55]
    v_add_u32_e64 v17, s37, v20
    v_mfma_f32_16x16x32_bf16 v[56:59], v[148:151], v[72:75], v[56:59]
    v_mfma_f32_16x16x32_bf16 v[60:63], v[148:151], v[76:79], v[60:63]
    buffer_load_dwordx4 v[148:151], v15, s[16:19], s34 offen offset:1024 sc1
    s_waitcnt vmcnt(14) lgkmcnt(0)
    s_nop 0
    v_mfma_f32_16x16x32_bf16 v[32:35], v[152:155], v[80:83], v[32:35]
    ds_read_b128 v[64:67], v17 offset:0
    v_mfma_f32_16x16x32_bf16 v[36:39], v[152:155], v[84:87], v[36:39]
    ds_read_b128 v[68:71], v17 offset:2048
    v_mfma_f32_16x16x32_bf16 v[40:43], v[152:155], v[88:91], v[40:43]
    ds_read_b128 v[72:75], v17 offset:4096
    v_mfma_f32_16x16x32_bf16 v[44:47], v[152:155], v[92:95], v[44:47]
    ds_read_b128 v[76:79], v17 offset:6144
    buffer_load_dwordx4 v[152:155], v16, s[16:19], s34 offen offset:0 sc1
    v_mfma_f32_16x16x32_bf16 v[48:51], v[156:159], v[80:83], v[48:51]
    v_min3_u32 v160, v160, v161, v162
    v_min3_u32 v164, v164, v165, v166
    v_add_u32 v18, s37, v21
    v_mfma_f32_16x16x32_bf16 v[52:55], v[156:159], v[84:87], v[52:55]
    v_min3_u32 v160, v160, v163, v167
    v_min_u32 v160, v160, v164
    v_mfma_f32_16x16x32_bf16 v[56:59], v[156:159], v[88:91], v[56:59]
    v_cmp_gt_u32 vcc, s36, v160
    v_mfma_f32_16x16x32_bf16 v[60:63], v[156:159], v[92:95], v[60:63]
    s_cbranch_vccnz L_pb_spin7
L_pb_ok7:
    buffer_load_dwordx4 v[156:159], v16, s[16:19], s34 offen offset:1024 sc1
    s_add_u32 s34, s34, 32768
    s_add_u32 s36, s36, 1
    s_cmp_lt_u32 s36, 24
    s_cbranch_scc1 L_p2
    s_mov_b32 s8, s52
    s_mov_b32 s9, s53
    s_mov_b32 s10, 0xc4000
    s_mov_b32 s11, 0x20000
    v_lshrrev_b32 v11, 3, v0
    v_and_b32 v10, 6, v11
    v_and_b32 v12, 7, v0
    v_xor_b32 v10, v10, v12
    v_lshlrev_b32 v10, 4, v10
    v_mul_u32_u24 v11, 896, v11
    v_add_u32 v10, v10, v11
    s_lshl_b32 s35, s29, 7
    s_mul_i32 s42, s32, 7168
    s_add_u32 s42, s42, s35
    s_lshl_b32 s43, s32, 10
    s_mul_i32 s24, s28, 112
    s_lshl_b32 s25, s29, 2
    s_add_u32 s25, s25, s32
    s_add_u32 s24, s24, s25
    s_lshl_b32 s24, s24, 10
    s_add_u32 s24, s24, 0x380000
    s_waitcnt vmcnt(14) lgkmcnt(0)
    s_nop 0
    v_mfma_f32_16x16x32_bf16 v[32:35], v[96:99], v[64:67], v[32:35]
    ds_read_b128 v[80:83], v18 offset:0
    v_mfma_f32_16x16x32_bf16 v[36:39], v[96:99], v[68:71], v[36:39]
    ds_read_b128 v[84:87], v18 offset:2048
    v_mfma_f32_16x16x32_bf16 v[40:43], v[96:99], v[72:75], v[40:43]
    ds_read_b128 v[88:91], v18 offset:4096
    v_mfma_f32_16x16x32_bf16 v[44:47], v[96:99], v[76:79], v[44:47]
    ds_read_b128 v[92:95], v18 offset:6144
    v_mfma_f32_16x16x32_bf16 v[48:51], v[100:103], v[64:67], v[48:51]
    ds_write_b32 v29, v23
    v_mfma_f32_16x16x32_bf16 v[52:55], v[100:103], v[68:71], v[52:55]
    v_mfma_f32_16x16x32_bf16 v[56:59], v[100:103], v[72:75], v[56:59]
    v_mfma_f32_16x16x32_bf16 v[60:63], v[100:103], v[76:79], v[60:63]
    s_waitcnt vmcnt(12) lgkmcnt(0)
    v_mfma_f32_16x16x32_bf16 v[32:35], v[104:107], v[80:83], v[32:35]
    ds_read_b128 v[64:67], v17 offset:8192
    s_nop 0
    v_mfma_f32_16x16x32_bf16 v[36:39], v[104:107], v[84:87], v[36:39]
    ds_read_b128 v[68:71], v17 offset:10240
    v_mfma_f32_16x16x32_bf16 v[40:43], v[104:107], v[88:91], v[40:43]
    ds_read_b128 v[72:75], v17 offset:12288
    v_mfma_f32_16x16x32_bf16 v[44:47], v[104:107], v[92:95], v[44:47]
    ds_read_b128 v[76:79], v17 offset:14336
    v_mfma_f32_16x16x32_bf16 v[48:51], v[108:111], v[80:83], v[48:51]
    v_add_u32_e64 v23, 1, v23
    v_mfma_f32_16x16x32_bf16 v[52:55], v[108:111], v[84:87], v[52:55]
    s_lshr_b64 s[38:39], s[38:39], 4
    s_and_b32 s37, s38, 15
    s_lshl_b32 s37, s37, 14
    v_mfma_f32_16x16x32_bf16 v[56:59], v[108:111], v[88:91], v[56:59]
    v_mfma_f32_16x16x32_bf16 v[60:63], v[108:111], v[92:95], v[60:63]
    s_waitcnt vmcnt(10) lgkmcnt(0)
    v_mfma_f32_16x16x32_bf16 v[32:35], v[112:115], v[64:67], v[32:35]
    ds_read_b128 v[80:83], v18 offset:8192
    v_mfma_f32_16x16x32_bf16 v[36:39], v[112:115], v[68:71], v[36:39]
    ds_read_b128 v[84:87], v18 offset:10240
    v_mfma_f32_16x16x32_bf16 v[40:43], v[112:115], v[72:75], v[40:43]
    ds_read_b128 v[88:91], v18 offset:12288
    v_mfma_f32_16x16x32_bf16 v[44:47], v[112:115], v[76:79], v[44:47]
    ds_read_b128 v[92:95], v18 offset:14336
    v_mfma_f32_16x16x32_bf16 v[48:51], v[116:119], v[64:67], v[48:51]
    ds_read_b128 v[160:163], v22
    ds_read_b128 v[164:167], v22 offset:16
    v_mfma_f32_16x16x32_bf16 v[52:55], v[116:119], v[68:71], v[52:55]
    v_add_u32 v17, s37, v20
    v_mfma_f32_16x16x32_bf16 v[56:59], v[116:119], v[72:75], v[56:59]
    v_mfma_f32_16x16x32_bf16 v[60:63], v[116:119], v[76:79], v[60:63]
    s_waitcnt vmcnt(8) lgkmcnt(0)
    v_mfma_f32_16x16x32_bf16 v[32:35], v[120:123], v[80:83], v[32:35]
    ds_read_b128 v[64:67], v17 offset:0
    v_mfma_f32_16x16x32_bf16 v[36:39], v[120:123], v[84:87], v[36:39]
    ds_read_b128 v[68:71], v17 offset:2048
    v_mfma_f32_16x16x32_bf16 v[40:43], v[120:123], v[88:91], v[40:43]
    ds_read_b128 v[72:75], v17 offset:4096
    v_mfma_f32_16x16x32_bf16 v[44:47], v[120:123], v[92:95], v[44:47]
    ds_read_b128 v[76:79], v17 offset:6144
    v_mfma_f32_16x16x32_bf16 v[48:51], v[124:127], v[80:83], v[48:51]
    v_min3_u32 v160, v160, v161, v162
    v_min3_u32 v164, v164, v165, v166
    v_add_u32_e64 v18, s37, v21
    v_mfma_f32_16x16x32_bf16 v[52:55], v[124:127], v[84:87], v[52:55]
    v_min3_u32 v160, v160, v163, v167
    v_min_u32 v160, v160, v164
    v_mfma_f32_16x16x32_bf16 v[56:59], v[124:127], v[88:91], v[56:59]
    v_cmp_gt_u32 vcc, s36, v160
    v_mfma_f32_16x16x32_bf16 v[60:63], v[124:127], v[92:95], v[60:63]
    s_cbranch_vccnz L_pc_spin3
L_pc_ok3:
    s_add_u32 s34, s34, 32768
    s_add_u32 s36, s36, 1
    s_waitcnt vmcnt(6) lgkmcnt(0)
    v_mfma_f32_16x16x32_bf16 v[32:35], v[128:131], v[64:67], v[32:35]
    ds_read_b128 v[80:83], v18 offset:0
    v_lshlrev_b32 v96, 16, v208
    v_mfma_f32_16x16x32_bf16 v[36:39], v[128:131], v[68:71], v[36:39]
    ds_read_b128 v[84:87], v18 offset:2048
    v_and_b32 v97, 0xffff0000, v208
    v_mfma_f32_16x16x32_bf16 v[40:43], v[128:131], v[72:75], v[40:43]
    ds_read_b128 v[88:91], v18 offset:4096
    v_lshlrev_b32_e64 v98, 16, v209
    v_mfma_f32_16x16x32_bf16 v[44:47], v[128:131], v[76:79], v[44:47]
    ds_read_b128 v[92:95], v18 offset:6144
    v_and_b32 v99, 0xffff0000, v209
    v_mfma_f32_16x16x32_bf16 v[48:51], v[132:135], v[64:67], v[48:51]
    ds_write_b32 v29, v23
    v_lshlrev_b32_e64 v100, 16, v210
    v_mfma_f32_16x16x32_bf16 v[52:55], v[132:135], v[68:71], v[52:55]
    v_and_b32 v101, 0xffff0000, v210
    v_mfma_f32_16x16x32_bf16 v[56:59], v[132:135], v[72:75], v[56:59]
    v_lshlrev_b32 v102, 16, v211
    v_mfma_f32_16x16x32_bf16 v[60:63], v[132:135], v[76:79], v[60:63]
    v_and_b32 v103, 0xffff0000, v211
    s_waitcnt vmcnt(4) lgkmcnt(0)
    v_mfma_f32_16x16x32_bf16 v[32:35], v[136:139], v[80:83], v[32:35]
    ds_read_b128 v[64:67], v17 offset:8192
    v_lshlrev_b32_e64 v104, 16, v212
    v_mfma_f32_16x16x32_bf16 v[36:39], v[136:139], v[84:87], v[36:39]
    ds_read_b128 v[68:71], v17 offset:10240
    v_and_b32 v105, 0xffff0000, v212
    v_mfma_f32_16x16x32_bf16 v[40:43], v[136:139], v[88:91], v[40:43]
    ds_read_b128 v[72:75], v17 offset:12288
    v_lshlrev_b32_e64 v106, 16, v213
    v_mfma_f32_16x16x32_bf16 v[44:47], v[136:139], v[92:95], v[44:47]
    ds_read_b128 v[76:79], v17 offset:14336
    v_and_b32 v107, 0xffff0000, v213
    v_mfma_f32_16x16x32_bf16 v[48:51], v[140:143], v[80:83], v[48:51]
    v_lshlrev_b32_e64 v108, 16, v214
    v_mfma_f32_16x16x32_bf16 v[52:55], v[140:143], v[84:87], v[52:55]
    v_and_b32 v109, 0xffff0000, v214
    v_mfma_f32_16x16x32_bf16 v[56:59], v[140:143], v[88:91], v[56:59]
    v_lshlrev_b32 v110, 16, v215
    v_mfma_f32_16x16x32_bf16 v[60:63], v[140:143], v[92:95], v[60:63]
    v_and_b32 v111, 0xffff0000, v215
    s_waitcnt vmcnt(2) lgkmcnt(0)
    v_mfma_f32_16x16x32_bf16 v[32:35], v[144:147], v[64:67], v[32:35]
    ds_read_b128 v[80:83], v18 offset:8192
    v_lshlrev_b32_e64 v112, 16, v216
    v_mfma_f32_16x16x32_bf16 v[36:39], v[144:147], v[68:71], v[36:39]
    ds_read_b128 v[84:87], v18 offset:10240
    v_and_b32 v113, 0xffff0000, v216
    v_mfma_f32_16x16x32_bf16 v[40:43], v[144:147], v[72:75], v[40:43]
    ds_read_b128 v[88:91], v18 offset:12288
    v_lshlrev_b32_e64 v114, 16, v217
    v_mfma_f32_16x16x32_bf16 v[44:47], v[144:147], v[76:79], v[44:47]
    ds_read_b128 v[92:95], v18 offset:14336
    v_and_b32 v115, 0xffff0000, v217
    v_mfma_f32_16x16x32_bf16 v[48:51], v[148:151], v[64:67], v[48:51]
    v_lshlrev_b32_e64 v116, 16, v218
    v_mfma_f32_16x16x32_bf16 v[52:55], v[148:151], v[68:71], v[52:55]
    v_and_b32 v117, 0xffff0000, v218
    v_mfma_f32_16x16x32_bf16 v[56:59], v[148:151], v[72:75], v[56:59]
    v_lshlrev_b32 v118, 16, v219
    v_mfma_f32_16x16x32_bf16 v[60:63], v[148:151], v[76:79], v[60:63]
    v_and_b32 v119, 0xffff0000, v219
    s_waitcnt vmcnt(0) lgkmcnt(0)
    v_mfma_f32_16x16x32_bf16 v[32:35], v[152:155], v[80:83], v[32:35]
    v_lshlrev_b32_e64 v120, 16, v220
    v_mfma_f32_16x16x32_bf16 v[36:39], v[152:155], v[84:87], v[36:39]
    v_and_b32 v121, 0xffff0000, v220
    v_mfma_f32_16x16x32_bf16 v[40:43], v[152:155], v[88:91], v[40:43]
    v_lshlrev_b32_e64 v122, 16, v221
    v_mfma_f32_16x16x32_bf16 v[44:47], v[152:155], v[92:95], v[44:47]
    v_and_b32 v123, 0xffff0000, v221
    v_mfma_f32_16x16x32_bf16 v[48:51], v[156:159], v[80:83], v[48:51]
    v_lshlrev_b32_e64 v124, 16, v222
    v_mfma_f32_16x16x32_bf16 v[52:55], v[156:159], v[84:87], v[52:55]
    v_and_b32 v125, 0xffff0000, v222
    v_mfma_f32_16x16x32_bf16 v[56:59], v[156:159], v[88:91], v[56:59]
    v_lshlrev_b32_e64 v126, 16, v223
    v_mfma_f32_16x16x32_bf16 v[60:63], v[156:159], v[92:95], v[60:63]
    v_and_b32 v127, 0xffff0000, v223
    s_add_u32 s34, s34, 32768
    s_add_u32 s36, s36, 1
    s_branch L_p2_done
L_z1_spin6:
    s_mov_b32 s62, 1048576
L_z1_spin6b:
    s_nop 0
    ds_read_b128 v[56:59], v22 offset:0
    s_waitcnt lgkmcnt(0)
    v_min3_u32 v56, v56, v57, v58
    v_min_u32 v56, v56, v59
    v_cmp_gt_u32 vcc, 5, v56
    s_cbranch_vccz L_z1_ok6
    s_sub_u32 s62, s62, 1
    s_cbranch_scc0 L_z1_spin6b
    s_branch L_z1_ok6
L_z1_spin8:
    s_mov_b32 s62, 1048576
L_z1_spin8b:
    ds_read_b128 v[56:59], v22 offset:0
    s_waitcnt lgkmcnt(0)
    v_min3_u32 v56, v56, v57, v58
    v_min_u32_e64 v56, v56, v59
    v_cmp_gt_u32 vcc, 6, v56
    s_cbranch_vccz L_z1_ok8
    s_sub_u32 s62, s62, 1
    s_cbranch_scc0 L_z1_spin8b
    s_branch L_z1_ok8
L_z1_spin12:
    s_mov_b32 s62, 1048576
L_z1_spin12b:
    ds_read_b128 v[56:59], v22 offset:0
    s_waitcnt lgkmcnt(0)
    v_min3_u32 v56, v56, v57, v58
    v_min_u32 v56, v56, v59
    v_cmp_gt_u32 vcc, 7, v56
    s_cbranch_vccz L_z1_ok12
    s_sub_u32 s62, s62, 1
    s_cbranch_scc0 L_z1_spin12b
    s_branch L_z1_ok12
L_pa0_spin3:
    s_mov_b32 s62, 1048576
L_pa0_spin3b:
    ds_read_b128 v[160:163], v22 offset:0
    ds_read_b128 v[164:167], v22 offset:16
    s_waitcnt lgkmcnt(0)
    v_min3_u32 v164, v164, v165, v166
    v_min3_u32 v160, v160, v164, v167
    v_min3_u32 v160, v160, v161, v162
    v_min_u32 v160, v160, v163
    v_cmp_gt_u32 vcc, s36, v160
    s_cbranch_vccz L_pa0_ok3
    s_sub_u32 s62, s62, 1
    s_cbranch_scc0 L_pa0_spin3b
    s_branch L_pa0_ok3
L_pa0_spin7:
    s_mov_b32 s62, 1048576
L_pa0_spin7b:
    ds_read_b128 v[160:163], v22 offset:0
    ds_read_b128 v[164:167], v22 offset:16
    s_waitcnt lgkmcnt(0)
    v_min3_u32 v164, v164, v165, v166
    v_min3_u32 v160, v160, v164, v167
    v_min3_u32 v160, v160, v161, v162
    v_min_u32 v160, v160, v163
    v_cmp_gt_u32 vcc, s36, v160
    s_cbranch_vccz L_pa0_ok7
    s_sub_u32 s62, s62, 1
    s_cbranch_scc0 L_pa0_spin7b
    s_branch L_pa0_ok7
L_pd_spin3:
    s_mov_b32 s62, 1048576
L_pd_spin3b:
    ds_read_b128 v[160:163], v22 offset:0
    ds_read_b128 v[164:167], v22 offset:16
    s_waitcnt lgkmcnt(0)
    v_min3_u32 v164, v164, v165, v166
    v_min3_u32 v160, v160, v164, v167
    v_min3_u32 v160, v160, v161, v162
    v_min_u32 v160, v160, v163
    v_cmp_gt_u32 vcc, s36, v160
    s_cbranch_vccz L_pd_ok3
    s_sub_u32 s62, s62, 1
    s_cbranch_scc0 L_pd_spin3b
    s_branch L_pd_ok3
L_pd_spin7:
    s_mov_b32 s62, 1048576
L_pd_spin7b:
    ds_read_b128 v[160:163], v22 offset:0
    ds_read_b128 v[164:167], v22 offset:16
    s_waitcnt lgkmcnt(0)
    v_min3_u32 v164, v164, v165, v166
    v_min3_u32 v160, v160, v164, v167
    v_min3_u32 v160, v160, v161, v162
    v_min_u32 v160, v160, v163
    v_cmp_gt_u32 vcc, s36, v160
    s_cbranch_vccz L_pd_ok7
    s_sub_u32 s62, s62, 1
    s_cbranch_scc0 L_pd_spin7b
    s_branch L_pd_ok7
L_pb_spin3:
    s_mov_b32 s62, 1048576
L_pb_spin3b:
    ds_read_b128 v[160:163], v22 offset:0
    ds_read_b128 v[164:167], v22 offset:16
    s_waitcnt lgkmcnt(0)
    v_min3_u32 v164, v164, v165, v166
    v_min3_u32 v160, v160, v164, v167
    v_min3_u32 v160, v160, v161, v162
    v_min_u32 v160, v160, v163
    v_cmp_gt_u32 vcc, s36, v160
    s_cbranch_vccz L_pb_ok3
    s_sub_u32 s62, s62, 1
    s_cbranch_scc0 L_pb_spin3b
    s_branch L_pb_ok3
L_pb_spin7:
    s_mov_b32 s62, 1048576
L_pb_spin7b:
    ds_read_b128 v[160:163], v22 offset:0
    ds_read_b128 v[164:167], v22 offset:16
    s_waitcnt lgkmcnt(0)
    v_min3_u32 v164, v164, v165, v166
    v_min3_u32 v160, v160, v164, v167
    v_min3_u32 v160, v160, v161, v162
    v_min_u32_e64 v160, v160, v163
    v_cmp_gt_u32 vcc, s36, v160
    s_cbranch_vccz L_pb_ok7
    s_sub_u32 s62, s62, 1
    s_cbranch_scc0 L_pb_spin7b
    s_branch L_pb_ok7
L_pc_spin3:
    s_mov_b32 s62, 1048576
L_pc_spin3b:
    ds_read_b128 v[160:163], v22 offset:0
    ds_read_b128 v[164:167], v22 offset:16
    s_waitcnt lgkmcnt(0)
    v_min3_u32 v164, v164, v165, v166
    v_min3_u32 v160, v160, v164, v167
    v_min3_u32 v160, v160, v161, v162
    v_min_u32 v160, v160, v163
    v_cmp_gt_u32 vcc, s36, v160
    s_cbranch_vccz L_pc_ok3
    s_sub_u32 s62, s62, 1
    s_cbranch_scc0 L_pc_spin3b
    s_branch L_pc_ok3
L_p2_done:
    v_pk_mul_f32 v[132:133], v[32:33], v[96:97]
    v_pk_mul_f32 v[134:135], v[34:35], v[98:99]
    s_nop 0
    v_pk_mul_f32 v[136:137], v[48:49], v[100:101]
    v_pk_mul_f32 v[138:139], v[50:51], v[102:103]
    v_cvt_pk_bf16_f32 v128, v132, v133
    v_cvt_pk_bf16_f32 v129, v134, v135
    v_cvt_pk_bf16_f32 v130, v136, v137
    v_cvt_pk_bf16_f32 v131, v138, v139
    buffer_store_dwordx4 v[128:131], v2, s[12:15], s24 offen sc1
    s_add_u32 s24, s24, 28672
    v_pk_mul_f32 v[144:145], v[36:37], v[104:105]
    v_pk_mul_f32 v[146:147], v[38:39], v[106:107]
    v_pk_mul_f32 v[148:149], v[52:53], v[108:109]
    v_pk_mul_f32 v[150:151], v[54:55], v[110:111]
    v_cvt_pk_bf16_f32 v140, v144, v145
    v_cvt_pk_bf16_f32 v141, v146, v147
    v_cvt_pk_bf16_f32 v142, v148, v149
    v_cvt_pk_bf16_f32 v143, v150, v151
    buffer_store_dwordx4 v[140:143], v2, s[12:15], s24 offen sc1
    s_add_u32 s24, s24, 28672
    v_pk_mul_f32 v[68:69], v[40:41], v[112:113]
    v_pk_mul_f32 v[70:71], v[42:43], v[114:115]
    v_pk_mul_f32 v[72:73], v[56:57], v[116:117]
    v_pk_mul_f32 v[74:75], v[58:59], v[118:119]
    v_cvt_pk_bf16_f32 v64, v68, v69
    v_cvt_pk_bf16_f32 v65, v70, v71
    v_cvt_pk_bf16_f32 v66, v72, v73
    v_cvt_pk_bf16_f32 v67, v74, v75
    buffer_store_dwordx4 v[64:67], v2, s[12:15], s24 offen sc1
    s_add_u32 s24, s24, 28672
    v_pk_mul_f32 v[80:81], v[44:45], v[120:121]
    v_pk_mul_f32 v[82:83], v[46:47], v[122:123]
    v_pk_mul_f32 v[84:85], v[60:61], v[124:125]
    v_pk_mul_f32 v[86:87], v[62:63], v[126:127]
    v_cvt_pk_bf16_f32 v76, v80, v81
    v_cvt_pk_bf16_f32 v77, v82, v83
    v_cvt_pk_bf16_f32 v78, v84, v85
    v_cvt_pk_bf16_f32 v79, v86, v87
    buffer_store_dwordx4 v[76:79], v2, s[12:15], s24 offen sc1
    s_add_u32 m0, s43, 65536
    s_add_u32 s35, s42, 458752
    buffer_load_dwordx4 v10, s[8:11], s35 offen lds
    s_add_u32 m0, s43, 69632
    s_add_u32 s35, s42, 487424
    buffer_load_dwordx4 v10, s[8:11], s35 offen lds
    s_add_u32 m0, s43, 73728
    s_add_u32 s35, s42, 516096
    buffer_load_dwordx4 v10, s[8:11], s35 offen lds
    s_add_u32 m0, s43, 77824
    s_add_u32 s35, s42, 544768
    buffer_load_dwordx4 v10, s[8:11], s35 offen lds
    s_lshl_b32 s33, s28, 2
    s_add_u32 s33, s33, s32
    s_lshl_b32 s37, s28, 11
    s_add_u32 s37, s37, 0xad4000
    s_lshl_b32 s36, s25, 6
    v_mov_b32 v12, s36
    s_waitcnt vmcnt(4)
    s_mov_b64 exec, 1
    buffer_store_dword v28, v12, s[12:15], s37 offen sc1
    s_mov_b64 exec, -1
    s_add_u32 m0, s43, 81920
    s_add_u32 s35, s42, 573440
    buffer_load_dwordx4 v10, s[8:11], s35 offen lds
    s_add_u32 m0, s43, 86016
    s_add_u32 s35, s42, 602112
    buffer_load_dwordx4 v10, s[8:11], s35 offen lds
    s_add_u32 m0, s43, 90112
    s_add_u32 s35, s42, 630784
    buffer_load_dwordx4 v10, s[8:11], s35 offen lds
    s_add_u32 m0, s43, 94208
    s_add_u32 s35, s42, 659456
    buffer_load_dwordx4 v10, s[8:11], s35 offen lds
    s_add_u32 m0, s43, 32768
    s_add_u32 s35, s42, 229376
    buffer_load_dwordx4 v10, s[8:11], s35 offen lds
    s_add_u32 m0, s43, 36864
    s_add_u32 s35, s42, 258048
    buffer_load_dwordx4 v10, s[8:11], s35 offen lds
    s_add_u32 m0, s43, 40960
    s_add_u32 s35, s42, 286720
    buffer_load_dwordx4 v10, s[8:11], s35 offen lds
    s_add_u32 m0, s43, 45056
    s_add_u32 s35, s42, 315392
    buffer_load_dwordx4 v10, s[8:11], s35 offen lds
    v_add_u32_e64 v14, s43, v2
    v_add_u32 v15, 0x10000, v14
    s_mov_b32 s62, 1048576
L_wa25:
    ds_read_b128 v[160:163], v22 offset:0
    s_waitcnt lgkmcnt(0)
    v_min3_u32 v160, v160, v161, v162
    v_min_u32 v160, v160, v163
    v_cmp_gt_u32 vcc, 25, v160
    s_cbranch_vccz L_wa25_ok
    s_sub_u32 s62, s62, 1
    s_cbranch_scc0 L_wa25
L_wa25_ok:
    ds_write_b128 v14, v[168:171] offset:49152
    ds_write_b128 v14, v[172:175] offset:53248
    ds_write_b128 v14, v[232:235] offset:57344
    ds_write_b128 v14, v[236:239] offset:61440
    ds_write_b128 v15, v[240:243] offset:32768
    ds_write_b128 v15, v[244:247] offset:36864
    ds_write_b128 v15, v[248:251] offset:40960
    ds_write_b128 v15, v[252:255] offset:45056
    ds_write_b128 v14, v[176:179] offset:0
    ds_write_b128 v14, v[180:183] offset:4096
    ds_write_b128 v14, v[184:187] offset:8192
    ds_write_b128 v14, v[188:191] offset:12288
    ds_write_b128 v14, v[192:195] offset:16384
    ds_write_b128 v14, v[196:199] offset:20480
    ds_write_b128 v14, v[200:203] offset:24576
    ds_write_b128 v14, v[204:207] offset:28672
    s_mov_b32 s16, s26
    s_mov_b32 s17, s27
    s_mov_b32 s18, 0x1c0000
    s_mov_b32 s19, 0x20000
    s_mul_i32 s34, s33, 28672
    s_add_u32 s34, s34, 0x380000
    v_lshrrev_b32 v10, 2, v0
    v_lshrrev_b32 v4, 1, v10
    v_and_b32 v4, 3, v4
    v_lshlrev_b32 v21, 5, v4
    v_and_b32 v13, 3, v0
    v_lshlrev_b32 v13, 3, v13
    v_lshl_add_u32 v13, v10, 7, v13
    v_xor_b32 v192, 0, v21
    v_add_u32 v192, v192, v13
    v_add_u32 v196, 0xe000, v192
    v_xor_b32 v193, 32, v21
    v_add_u32 v193, v193, v13
    v_add_u32 v197, 0xe000, v193
    v_xor_b32 v194, 64, v21
    v_add_u32 v194, v194, v13
    v_add_u32 v198, 0xe000, v194
    v_xor_b32 v195, 96, v21
    v_add_u32_e64 v195, v195, v13
    v_add_u32 v199, 0xe000, v195
    s_cmp_lg_u32 s3, 0
    s_cbranch_scc1 L_nofh
    s_mov_b32 s62, 65536
    s_mov_b32 exec_lo, 0x0fffffff
    s_mov_b32 exec_hi, 0
L_pfh:
    buffer_load_dword v20, v19, s[12:15], s37 offen sc1
    s_waitcnt vmcnt(0)
L_pfh_chk:
    v_cmp_ne_u32 vcc, v28, v20
    s_cbranch_vccz L_pfh_ok
    s_sleep 1
    s_sub_u32 s62, s62, 1
    s_cbranch_scc0 L_pfh
L_pfh_ok:
    s_mov_b64 exec, -1
L_nofh:
    s_waitcnt vmcnt(0) lgkmcnt(0)
    v_mov_b32 v23, 26
    ds_write_b32 v29, v23
    s_mov_b32 s62, 1048576
L_wa26:
    ds_read_b128 v[160:163], v22 offset:0
    s_waitcnt lgkmcnt(0)
    v_min3_u32 v160, v160, v161, v162
    v_min_u32 v160, v160, v163
    v_cmp_gt_u32 vcc, 26, v160
    s_cbranch_vccz L_wa26_ok
    s_sub_u32 s62, s62, 1
    s_cbranch_scc0 L_wa26
L_wa26_ok:
    s_add_u32 s38, s34, 0
    buffer_load_dwordx4 v[32:35], v2, s[12:15], s38 offen offset:0 sc1
    buffer_load_dwordx4 v[36:39], v2, s[12:15], s38 offen offset:1024 sc1
    s_nop 0
    buffer_load_dwordx4 v[40:43], v2, s[12:15], s38 offen offset:2048 sc1
    buffer_load_dwordx4 v[44:47], v2, s[12:15], s38 offen offset:3072 sc1
    s_add_u32 s38, s34, 4096
    buffer_load_dwordx4 v[48:51], v2, s[12:15], s38 offen offset:0 sc1
    buffer_load_dwordx4 v[52:55], v2, s[12:15], s38 offen offset:1024 sc1
    buffer_load_dwordx4 v[56:59], v2, s[12:15], s38 offen offset:2048 sc1
    buffer_load_dwordx4 v[60:63], v2, s[12:15], s38 offen offset:3072 sc1
    s_add_u32 s38, s34, 8192
    buffer_load_dwordx4 v[64:67], v2, s[12:15], s38 offen offset:0 sc1
    buffer_load_dwordx4 v[68:71], v2, s[12:15], s38 offen offset:1024 sc1
    ds_read_b64_tr_b16 v[160:161], v192 offset:0
    ds_read_b64_tr_b16 v[162:163], v192 offset:2048
    ds_read_b64_tr_b16 v[164:165], v193 offset:0
    ds_read_b64_tr_b16 v[166:167], v193 offset:2048
    ds_read_b64_tr_b16 v[168:169], v194 offset:0
    ds_read_b64_tr_b16 v[170:171], v194 offset:2048
    ds_read_b64_tr_b16 v[172:173], v195 offset:0
    ds_read_b64_tr_b16 v[174:175], v195 offset:2048
    s_lshl_b32 s36, s32, 5
    v_xor_b32 v12, s36, v21
    v_add_u32_e64 v12, v12, v13
    v_add_u32 v12, 148480, v12
    s_lshl_b32 s36, s32, 7
    s_add_u32 s36, s36, 156672
    v_lshlrev_b32 v11, 3, v8
    v_add_u32_e64 v11, s36, v11
    v_mul_u32_u24 v10, 896, v8
    v_lshrrev_b32 v14, 1, v9
    v_lshl_add_u32 v10, v14, 4, v10
    v_and_b32 v14, 1, v9
    v_lshl_add_u32 v10, v14, 5, v10
    s_mul_i32 s36, s33, 14336
    s_lshl_b32 s37, s29, 7
    s_add_u32 s36, s36, s37
    s_waitcnt vmcnt(9) lgkmcnt(4)
    v_mfma_f32_16x16x32_bf16 v[144:147], v[160:163], v[32:35], 0
    ds_read_b64_tr_b16 v[176:177], v192 offset:4096
    ds_read_b64_tr_b16 v[178:179], v192 offset:6144
    v_mfma_f32_16x16x32_bf16 v[148:151], v[164:167], v[32:35], 0
    ds_read_b64_tr_b16 v[180:181], v193 offset:4096
    ds_read_b64_tr_b16 v[182:183], v193 offset:6144
    s_waitcnt lgkmcnt(4)
    v_mfma_f32_16x16x32_bf16 v[152:155], v[168:171], v[32:35], 0
    ds_read_b64_tr_b16 v[184:185], v194 offset:4096
    ds_read_b64_tr_b16 v[186:187], v194 offset:6144
    v_mfma_f32_16x16x32_bf16 v[156:159], v[172:175], v[32:35], 0
    ds_read_b64_tr_b16 v[188:189], v195 offset:4096
    ds_read_b64_tr_b16 v[190:191], v195 offset:6144
    buffer_load_dwordx4 v[72:75], v2, s[12:15], s38 offen offset:2048 sc1
    s_waitcnt vmcnt(9) lgkmcnt(4)
    v_mfma_f32_16x16x32_bf16 v[144:147], v[176:179], v[36:39], v[144:147]
    ds_read_b64_tr_b16 v[160:161], v192 offset:8192
    ds_read_b64_tr_b16 v[162:163], v192 offset:10240
    v_mfma_f32_16x16x32_bf16 v[148:151], v[180:183], v[36:39], v[148:151]
    ds_read_b64_tr_b16 v[164:165], v193 offset:8192
    ds_read_b64_tr_b16 v[166:167], v193 offset:10240
    s_waitcnt lgkmcnt(4)
    v_mfma_f32_16x16x32_bf16 v[152:155], v[184:187], v[36:39], v[152:155]
    ds_read_b64_tr_b16 v[168:169], v194 offset:8192
    ds_read_b64_tr_b16 v[170:171], v194 offset:10240
    v_mfma_f32_16x16x32_bf16 v[156:159], v[188:191], v[36:39], v[156:159]
    ds_read_b64_tr_b16 v[172:173], v195 offset:8192
    ds_read_b64_tr_b16 v[174:175], v195 offset:10240
    buffer_load_dwordx4 v[76:79], v2, s[12:15], s38 offen offset:3072 sc1
    s_waitcnt vmcnt(9) lgkmcnt(4)
    v_mfma_f32_16x16x32_bf16 v[144:147], v[160:163], v[40:43], v[144:147]
    ds_read_b64_tr_b16 v[176:177], v192 offset:12288
    ds_read_b64_tr_b16 v[178:179], v192 offset:14336
    v_mfma_f32_16x16x32_bf16 v[148:151], v[164:167], v[40:43], v[148:151]
    ds_read_b64_tr_b16 v[180:181], v193 offset:12288
    ds_read_b64_tr_b16 v[182:183], v193 offset:14336
    s_waitcnt lgkmcnt(4)
    v_mfma_f32_16x16x32_bf16 v[152:155], v[168:171], v[40:43], v[152:155]
    ds_read_b64_tr_b16 v[184:185], v194 offset:12288
    ds_read_b64_tr_b16 v[186:187], v194 offset:14336
    v_mfma_f32_16x16x32_bf16 v[156:159], v[172:175], v[40:43], v[156:159]
    ds_read_b64_tr_b16 v[188:189], v195 offset:12288
    ds_read_b64_tr_b16 v[190:191], v195 offset:14336
    s_add_u32 s38, s34, 12288
    buffer_load_dwordx4 v[80:83], v2, s[12:15], s38 offen offset:0 sc1
    s_waitcnt vmcnt(9) lgkmcnt(4)
    v_mfma_f32_16x16x32_bf16 v[144:147], v[176:179], v[44:47], v[144:147]
    ds_read_b64_tr_b16 v[160:161], v192 offset:16384
    ds_read_b64_tr_b16 v[162:163], v192 offset:18432
    v_mfma_f32_16x16x32_bf16 v[148:151], v[180:183], v[44:47], v[148:151]
    ds_read_b64_tr_b16 v[164:165], v193 offset:16384
    ds_read_b64_tr_b16 v[166:167], v193 offset:18432
    s_waitcnt lgkmcnt(4)
    v_mfma_f32_16x16x32_bf16 v[152:155], v[184:187], v[44:47], v[152:155]
    ds_read_b64_tr_b16 v[168:169], v194 offset:16384
    ds_read_b64_tr_b16 v[170:171], v194 offset:18432
    v_mfma_f32_16x16x32_bf16 v[156:159], v[188:191], v[44:47], v[156:159]
    ds_read_b64_tr_b16 v[172:173], v195 offset:16384
    ds_read_b64_tr_b16 v[174:175], v195 offset:18432
    buffer_load_dwordx4 v[84:87], v2, s[12:15], s38 offen offset:1024 sc1
    s_waitcnt vmcnt(9) lgkmcnt(4)
    v_mfma_f32_16x16x32_bf16 v[144:147], v[160:163], v[48:51], v[144:147]
    ds_read_b64_tr_b16 v[176:177], v192 offset:20480
    ds_read_b64_tr_b16 v[178:179], v192 offset:22528
    v_mfma_f32_16x16x32_bf16 v[148:151], v[164:167], v[48:51], v[148:151]
    ds_read_b64_tr_b16 v[180:181], v193 offset:20480
    ds_read_b64_tr_b16 v[182:183], v193 offset:22528
    s_waitcnt lgkmcnt(4)
    v_mfma_f32_16x16x32_bf16 v[152:155], v[168:171], v[48:51], v[152:155]
    ds_read_b64_tr_b16 v[184:185], v194 offset:20480
    ds_read_b64_tr_b16 v[186:187], v194 offset:22528
    v_mfma_f32_16x16x32_bf16 v[156:159], v[172:175], v[48:51], v[156:159]
    ds_read_b64_tr_b16 v[188:189], v195 offset:20480
    ds_read_b64_tr_b16 v[190:191], v195 offset:22528
    buffer_load_dwordx4 v[88:91], v2, s[12:15], s38 offen offset:2048 sc1
    s_waitcnt vmcnt(9) lgkmcnt(4)
    v_mfma_f32_16x16x32_bf16 v[144:147], v[176:179], v[52:55], v[144:147]
    ds_read_b64_tr_b16 v[160:161], v192 offset:24576
    ds_read_b64_tr_b16 v[162:163], v192 offset:26624
    v_mfma_f32_16x16x32_bf16 v[148:151], v[180:183], v[52:55], v[148:151]
    ds_read_b64_tr_b16 v[164:165], v193 offset:24576
    ds_read_b64_tr_b16 v[166:167], v193 offset:26624
    s_waitcnt lgkmcnt(4)
    v_mfma_f32_16x16x32_bf16 v[152:155], v[184:187], v[52:55], v[152:155]
    ds_read_b64_tr_b16 v[168:169], v194 offset:24576
    ds_read_b64_tr_b16 v[170:171], v194 offset:26624
    v_mfma_f32_16x16x32_bf16 v[156:159], v[188:191], v[52:55], v[156:159]
    ds_read_b64_tr_b16 v[172:173], v195 offset:24576
    ds_read_b64_tr_b16 v[174:175], v195 offset:26624
    buffer_load_dwordx4 v[92:95], v2, s[12:15], s38 offen offset:3072 sc1
    s_waitcnt vmcnt(9) lgkmcnt(4)
    v_mfma_f32_16x16x32_bf16 v[144:147], v[160:163], v[56:59], v[144:147]
    ds_read_b64_tr_b16 v[176:177], v192 offset:28672
    ds_read_b64_tr_b16 v[178:179], v192 offset:30720
    v_mfma_f32_16x16x32_bf16 v[148:151], v[164:167], v[56:59], v[148:151]
    ds_read_b64_tr_b16 v[180:181], v193 offset:28672
    ds_read_b64_tr_b16 v[182:183], v193 offset:30720
    s_waitcnt lgkmcnt(4)
    v_mfma_f32_16x16x32_bf16 v[152:155], v[168:171], v[56:59], v[152:155]
    ds_read_b64_tr_b16 v[184:185], v194 offset:28672
    ds_read_b64_tr_b16 v[186:187], v194 offset:30720
    v_mfma_f32_16x16x32_bf16 v[156:159], v[172:175], v[56:59], v[156:159]
    ds_read_b64_tr_b16 v[188:189], v195 offset:28672
    ds_read_b64_tr_b16 v[190:191], v195 offset:30720
    s_add_u32 s38, s34, 16384
    buffer_load_dwordx4 v[96:99], v2, s[12:15], s38 offen offset:0 sc1
    s_waitcnt vmcnt(9) lgkmcnt(4)
    v_mfma_f32_16x16x32_bf16 v[144:147], v[176:179], v[60:63], v[144:147]
    ds_read_b64_tr_b16 v[160:161], v192 offset:32768
    ds_read_b64_tr_b16 v[162:163], v192 offset:34816
    v_mfma_f32_16x16x32_bf16 v[148:151], v[180:183], v[60:63], v[148:151]
    ds_read_b64_tr_b16 v[164:165], v193 offset:32768
    ds_read_b64_tr_b16 v[166:167], v193 offset:34816
    s_waitcnt lgkmcnt(4)
    v_mfma_f32_16x16x32_bf16 v[152:155], v[184:187], v[60:63], v[152:155]
    ds_read_b64_tr_b16 v[168:169], v194 offset:32768
    ds_read_b64_tr_b16 v[170:171], v194 offset:34816
    v_mfma_f32_16x16x32_bf16 v[156:159], v[188:191], v[60:63], v[156:159]
    ds_read_b64_tr_b16 v[172:173], v195 offset:32768
    ds_read_b64_tr_b16 v[174:175], v195 offset:34816
    buffer_load_dwordx4 v[100:103], v2, s[12:15], s38 offen offset:1024 sc1
    s_waitcnt vmcnt(9) lgkmcnt(4)
    v_mfma_f32_16x16x32_bf16 v[144:147], v[160:163], v[64:67], v[144:147]
    ds_read_b64_tr_b16 v[176:177], v192 offset:36864
    ds_read_b64_tr_b16 v[178:179], v192 offset:38912
    v_mfma_f32_16x16x32_bf16 v[148:151], v[164:167], v[64:67], v[148:151]
    ds_read_b64_tr_b16 v[180:181], v193 offset:36864
    ds_read_b64_tr_b16 v[182:183], v193 offset:38912
    s_waitcnt lgkmcnt(4)
    v_mfma_f32_16x16x32_bf16 v[152:155], v[168:171], v[64:67], v[152:155]
    ds_read_b64_tr_b16 v[184:185], v194 offset:36864
    ds_read_b64_tr_b16 v[186:187], v194 offset:38912
    v_mfma_f32_16x16x32_bf16 v[156:159], v[172:175], v[64:67], v[156:159]
    ds_read_b64_tr_b16 v[188:189], v195 offset:36864
    ds_read_b64_tr_b16 v[190:191], v195 offset:38912
    buffer_load_dwordx4 v[104:107], v2, s[12:15], s38 offen offset:2048 sc1
    s_waitcnt vmcnt(9) lgkmcnt(4)
    v_mfma_f32_16x16x32_bf16 v[144:147], v[176:179], v[68:71], v[144:147]
    ds_read_b64_tr_b16 v[160:161], v192 offset:40960
    ds_read_b64_tr_b16 v[162:163], v192 offset:43008
    v_mfma_f32_16x16x32_bf16 v[148:151], v[180:183], v[68:71], v[148:151]
    ds_read_b64_tr_b16 v[164:165], v193 offset:40960
    ds_read_b64_tr_b16 v[166:167], v193 offset:43008
    s_waitcnt lgkmcnt(4)
    v_mfma_f32_16x16x32_bf16 v[152:155], v[184:187], v[68:71], v[152:155]
    ds_read_b64_tr_b16 v[168:169], v194 offset:40960
    ds_read_b64_tr_b16 v[170:171], v194 offset:43008
    v_mfma_f32_16x16x32_bf16 v[156:159], v[188:191], v[68:71], v[156:159]
    ds_read_b64_tr_b16 v[172:173], v195 offset:40960
    ds_read_b64_tr_b16 v[174:175], v195 offset:43008
    buffer_load_dwordx4 v[108:111], v2, s[12:15], s38 offen offset:3072 sc1
    s_waitcnt vmcnt(9) lgkmcnt(4)
    v_mfma_f32_16x16x32_bf16 v[144:147], v[160:163], v[72:75], v[144:147]
    ds_read_b64_tr_b16 v[176:177], v192 offset:45056
    ds_read_b64_tr_b16 v[178:179], v192 offset:47104
    v_mfma_f32_16x16x32_bf16 v[148:151], v[164:167], v[72:75], v[148:151]
    ds_read_b64_tr_b16 v[180:181], v193 offset:45056
    ds_read_b64_tr_b16 v[182:183], v193 offset:47104
    s_waitcnt lgkmcnt(4)
    v_mfma_f32_16x16x32_bf16 v[152:155], v[168:171], v[72:75], v[152:155]
    ds_read_b64_tr_b16 v[184:185], v194 offset:45056
    ds_read_b64_tr_b16 v[186:187], v194 offset:47104
    v_mfma_f32_16x16x32_bf16 v[156:159], v[172:175], v[72:75], v[156:159]
    ds_read_b64_tr_b16 v[188:189], v195 offset:45056
    ds_read_b64_tr_b16 v[190:191], v195 offset:47104
    s_add_u32 s38, s34, 20480
    buffer_load_dwordx4 v[112:115], v2, s[12:15], s38 offen offset:0 sc1
    s_waitcnt vmcnt(9) lgkmcnt(4)
    v_mfma_f32_16x16x32_bf16 v[144:147], v[176:179], v[76:79], v[144:147]
    ds_read_b64_tr_b16 v[160:161], v192 offset:49152
    ds_read_b64_tr_b16 v[162:163], v192 offset:51200
    v_mfma_f32_16x16x32_bf16 v[148:151], v[180:183], v[76:79], v[148:151]
    ds_read_b64_tr_b16 v[164:165], v193 offset:49152
    ds_read_b64_tr_b16 v[166:167], v193 offset:51200
    s_waitcnt lgkmcnt(4)
    v_mfma_f32_16x16x32_bf16 v[152:155], v[184:187], v[76:79], v[152:155]
    ds_read_b64_tr_b16 v[168:169], v194 offset:49152
    ds_read_b64_tr_b16 v[170:171], v194 offset:51200
    v_mfma_f32_16x16x32_bf16 v[156:159], v[188:191], v[76:79], v[156:159]
    ds_read_b64_tr_b16 v[172:173], v195 offset:49152
    ds_read_b64_tr_b16 v[174:175], v195 offset:51200
    buffer_load_dwordx4 v[116:119], v2, s[12:15], s38 offen offset:1024 sc1
    s_waitcnt vmcnt(9) lgkmcnt(4)
    v_mfma_f32_16x16x32_bf16 v[144:147], v[160:163], v[80:83], v[144:147]
    ds_read_b64_tr_b16 v[176:177], v192 offset:53248
    ds_read_b64_tr_b16 v[178:179], v192 offset:55296
    v_mfma_f32_16x16x32_bf16 v[148:151], v[164:167], v[80:83], v[148:151]
    ds_read_b64_tr_b16 v[180:181], v193 offset:53248
    ds_read_b64_tr_b16 v[182:183], v193 offset:55296
    s_waitcnt lgkmcnt(4)
    v_mfma_f32_16x16x32_bf16 v[152:155], v[168:171], v[80:83], v[152:155]
    ds_read_b64_tr_b16 v[184:185], v194 offset:53248
    ds_read_b64_tr_b16 v[186:187], v194 offset:55296
    v_mfma_f32_16x16x32_bf16 v[156:159], v[172:175], v[80:83], v[156:159]
    ds_read_b64_tr_b16 v[188:189], v195 offset:53248
    ds_read_b64_tr_b16 v[190:191], v195 offset:55296
    buffer_load_dwordx4 v[120:123], v2, s[12:15], s38 offen offset:2048 sc1
    s_waitcnt vmcnt(9) lgkmcnt(4)
    v_mfma_f32_16x16x32_bf16 v[144:147], v[176:179], v[84:87], v[144:147]
    ds_read_b64_tr_b16 v[160:161], v196 offset:0
    ds_read_b64_tr_b16 v[162:163], v196 offset:2048
    v_mfma_f32_16x16x32_bf16 v[148:151], v[180:183], v[84:87], v[148:151]
    ds_read_b64_tr_b16 v[164:165], v197 offset:0
    ds_read_b64_tr_b16 v[166:167], v197 offset:2048
    s_waitcnt lgkmcnt(4)
    v_mfma_f32_16x16x32_bf16 v[152:155], v[184:187], v[84:87], v[152:155]
    ds_read_b64_tr_b16 v[168:169], v198 offset:0
    ds_read_b64_tr_b16 v[170:171], v198 offset:2048
    v_mfma_f32_16x16x32_bf16 v[156:159], v[188:191], v[84:87], v[156:159]
    ds_read_b64_tr_b16 v[172:173], v199 offset:0
    ds_read_b64_tr_b16 v[174:175], v199 offset:2048
    buffer_load_dwordx4 v[124:127], v2, s[12:15], s38 offen offset:3072 sc1
    s_waitcnt vmcnt(9) lgkmcnt(4)
    v_mfma_f32_16x16x32_bf16 v[144:147], v[160:163], v[88:91], v[144:147]
    ds_read_b64_tr_b16 v[176:177], v196 offset:4096
    ds_read_b64_tr_b16 v[178:179], v196 offset:6144
    v_mfma_f32_16x16x32_bf16 v[148:151], v[164:167], v[88:91], v[148:151]
    ds_read_b64_tr_b16 v[180:181], v197 offset:4096
    ds_read_b64_tr_b16 v[182:183], v197 offset:6144
    s_waitcnt lgkmcnt(4)
    v_mfma_f32_16x16x32_bf16 v[152:155], v[168:171], v[88:91], v[152:155]
    ds_read_b64_tr_b16 v[184:185], v198 offset:4096
    ds_read_b64_tr_b16 v[186:187], v198 offset:6144
    v_mfma_f32_16x16x32_bf16 v[156:159], v[172:175], v[88:91], v[156:159]
    ds_read_b64_tr_b16 v[188:189], v199 offset:4096
    ds_read_b64_tr_b16 v[190:191], v199 offset:6144
    s_add_u32 s38, s34, 24576
    buffer_load_dwordx4 v[128:131], v2, s[12:15], s38 offen offset:0 sc1
    s_waitcnt vmcnt(9) lgkmcnt(4)
    v_mfma_f32_16x16x32_bf16 v[144:147], v[176:179], v[92:95], v[144:147]
    ds_read_b64_tr_b16 v[160:161], v196 offset:8192
    ds_read_b64_tr_b16 v[162:163], v196 offset:10240
    v_mfma_f32_16x16x32_bf16 v[148:151], v[180:183], v[92:95], v[148:151]
    ds_read_b64_tr_b16 v[164:165], v197 offset:8192
    ds_read_b64_tr_b16 v[166:167], v197 offset:10240
    s_waitcnt lgkmcnt(4)
    v_mfma_f32_16x16x32_bf16 v[152:155], v[184:187], v[92:95], v[152:155]
    ds_read_b64_tr_b16 v[168:169], v198 offset:8192
    ds_read_b64_tr_b16 v[170:171], v198 offset:10240
    v_mfma_f32_16x16x32_bf16 v[156:159], v[188:191], v[92:95], v[156:159]
    ds_read_b64_tr_b16 v[172:173], v199 offset:8192
    ds_read_b64_tr_b16 v[174:175], v199 offset:10240
    buffer_load_dwordx4 v[132:135], v2, s[12:15], s38 offen offset:1024 sc1
    s_waitcnt vmcnt(9) lgkmcnt(4)
    v_mfma_f32_16x16x32_bf16 v[144:147], v[160:163], v[96:99], v[144:147]
    ds_read_b64_tr_b16 v[176:177], v196 offset:12288
    ds_read_b64_tr_b16 v[178:179], v196 offset:14336
    v_mfma_f32_16x16x32_bf16 v[148:151], v[164:167], v[96:99], v[148:151]
    ds_read_b64_tr_b16 v[180:181], v197 offset:12288
    ds_read_b64_tr_b16 v[182:183], v197 offset:14336
    s_waitcnt lgkmcnt(4)
    v_mfma_f32_16x16x32_bf16 v[152:155], v[168:171], v[96:99], v[152:155]
    ds_read_b64_tr_b16 v[184:185], v198 offset:12288
    ds_read_b64_tr_b16 v[186:187], v198 offset:14336
    v_mfma_f32_16x16x32_bf16 v[156:159], v[172:175], v[96:99], v[156:159]
    ds_read_b64_tr_b16 v[188:189], v199 offset:12288
    ds_read_b64_tr_b16 v[190:191], v199 offset:14336
    buffer_load_dwordx4 v[136:139], v2, s[12:15], s38 offen offset:2048 sc1
    s_waitcnt vmcnt(9) lgkmcnt(4)
    v_mfma_f32_16x16x32_bf16 v[144:147], v[176:179], v[100:103], v[144:147]
    ds_read_b64_tr_b16 v[160:161], v196 offset:16384
    ds_read_b64_tr_b16 v[162:163], v196 offset:18432
    v_mfma_f32_16x16x32_bf16 v[148:151], v[180:183], v[100:103], v[148:151]
    ds_read_b64_tr_b16 v[164:165], v197 offset:16384
    ds_read_b64_tr_b16 v[166:167], v197 offset:18432
    s_waitcnt lgkmcnt(4)
    v_mfma_f32_16x16x32_bf16 v[152:155], v[184:187], v[100:103], v[152:155]
    ds_read_b64_tr_b16 v[168:169], v198 offset:16384
    ds_read_b64_tr_b16 v[170:171], v198 offset:18432
    v_mfma_f32_16x16x32_bf16 v[156:159], v[188:191], v[100:103], v[156:159]
    ds_read_b64_tr_b16 v[172:173], v199 offset:16384
    ds_read_b64_tr_b16 v[174:175], v199 offset:18432
    buffer_load_dwordx4 v[140:143], v2, s[12:15], s38 offen offset:3072 sc1
    s_waitcnt vmcnt(9) lgkmcnt(4)
    v_mfma_f32_16x16x32_bf16 v[144:147], v[160:163], v[104:107], v[144:147]
    ds_read_b64_tr_b16 v[176:177], v196 offset:20480
    ds_read_b64_tr_b16 v[178:179], v196 offset:22528
    v_mfma_f32_16x16x32_bf16 v[148:151], v[164:167], v[104:107], v[148:151]
    ds_read_b64_tr_b16 v[180:181], v197 offset:20480
    ds_read_b64_tr_b16 v[182:183], v197 offset:22528
    s_waitcnt lgkmcnt(4)
    v_mfma_f32_16x16x32_bf16 v[152:155], v[168:171], v[104:107], v[152:155]
    ds_read_b64_tr_b16 v[184:185], v198 offset:20480
    ds_read_b64_tr_b16 v[186:187], v198 offset:22528
    v_mfma_f32_16x16x32_bf16 v[156:159], v[172:175], v[104:107], v[156:159]
    ds_read_b64_tr_b16 v[188:189], v199 offset:20480
    ds_read_b64_tr_b16 v[190:191], v199 offset:22528
    s_waitcnt vmcnt(8) lgkmcnt(4)
    v_mfma_f32_16x16x32_bf16 v[144:147], v[176:179], v[108:111], v[144:147]
    ds_read_b64_tr_b16 v[160:161], v196 offset:24576
    ds_read_b64_tr_b16 v[162:163], v196 offset:26624
    v_mfma_f32_16x16x32_bf16 v[148:151], v[180:183], v[108:111], v[148:151]
    ds_read_b64_tr_b16 v[164:165], v197 offset:24576
    ds_read_b64_tr_b16 v[166:167], v197 offset:26624
    s_waitcnt lgkmcnt(4)
    v_mfma_f32_16x16x32_bf16 v[152:155], v[184:187], v[108:111], v[152:155]
    ds_read_b64_tr_b16 v[168:169], v198 offset:24576
    ds_read_b64_tr_b16 v[170:171], v198 offset:26624
    v_mfma_f32_16x16x32_bf16 v[156:159], v[188:191], v[108:111], v[156:159]
    ds_read_b64_tr_b16 v[172:173], v199 offset:24576
    ds_read_b64_tr_b16 v[174:175], v199 offset:26624
    s_waitcnt vmcnt(7) lgkmcnt(4)
    v_mfma_f32_16x16x32_bf16 v[144:147], v[160:163], v[112:115], v[144:147]
    ds_read_b64_tr_b16 v[176:177], v196 offset:28672
    ds_read_b64_tr_b16 v[178:179], v196 offset:30720
    v_mfma_f32_16x16x32_bf16 v[148:151], v[164:167], v[112:115], v[148:151]
    ds_read_b64_tr_b16 v[180:181], v197 offset:28672
    ds_read_b64_tr_b16 v[182:183], v197 offset:30720
    s_waitcnt lgkmcnt(4)
    v_mfma_f32_16x16x32_bf16 v[152:155], v[168:171], v[112:115], v[152:155]
    ds_read_b64_tr_b16 v[184:185], v198 offset:28672
    ds_read_b64_tr_b16 v[186:187], v198 offset:30720
    v_mfma_f32_16x16x32_bf16 v[156:159], v[172:175], v[112:115], v[156:159]
    ds_read_b64_tr_b16 v[188:189], v199 offset:28672
    ds_read_b64_tr_b16 v[190:191], v199 offset:30720
    s_waitcnt vmcnt(6) lgkmcnt(4)
    v_mfma_f32_16x16x32_bf16 v[144:147], v[176:179], v[116:119], v[144:147]
    ds_read_b64_tr_b16 v[160:161], v196 offset:32768
    ds_read_b64_tr_b16 v[162:163], v196 offset:34816
    v_mfma_f32_16x16x32_bf16 v[148:151], v[180:183], v[116:119], v[148:151]
    ds_read_b64_tr_b16 v[164:165], v197 offset:32768
    ds_read_b64_tr_b16 v[166:167], v197 offset:34816
    s_waitcnt lgkmcnt(4)
    v_mfma_f32_16x16x32_bf16 v[152:155], v[184:187], v[116:119], v[152:155]
    ds_read_b64_tr_b16 v[168:169], v198 offset:32768
    ds_read_b64_tr_b16 v[170:171], v198 offset:34816
    v_mfma_f32_16x16x32_bf16 v[156:159], v[188:191], v[116:119], v[156:159]
    ds_read_b64_tr_b16 v[172:173], v199 offset:32768
    ds_read_b64_tr_b16 v[174:175], v199 offset:34816
    s_barrier
    ds_read_b64 v[4:5], v11
    ds_read_b64_tr_b16 v[32:33], v12 offset:0
    ds_read_b64_tr_b16 v[34:35], v12 offset:2048
    ds_read_b64_tr_b16 v[36:37], v12 offset:4096
    ds_read_b64_tr_b16 v[38:39], v12 offset:6144
    s_waitcnt vmcnt(5) lgkmcnt(4)
    v_mfma_f32_16x16x32_bf16 v[144:147], v[160:163], v[120:123], v[144:147]
    ds_read_b64_tr_b16 v[176:177], v196 offset:36864
    ds_read_b64_tr_b16 v[178:179], v196 offset:38912
    v_mfma_f32_16x16x32_bf16 v[148:151], v[164:167], v[120:123], v[148:151]
    ds_read_b64_tr_b16 v[180:181], v197 offset:36864
    ds_read_b64_tr_b16 v[182:183], v197 offset:38912
    s_waitcnt lgkmcnt(4)
    v_mfma_f32_16x16x32_bf16 v[152:155], v[168:171], v[120:123], v[152:155]
    ds_read_b64_tr_b16 v[184:185], v198 offset:36864
    ds_read_b64_tr_b16 v[186:187], v198 offset:38912
    v_mfma_f32_16x16x32_bf16 v[156:159], v[172:175], v[120:123], v[156:159]
    ds_read_b64_tr_b16 v[188:189], v199 offset:36864
    ds_read_b64_tr_b16 v[190:191], v199 offset:38912
    s_waitcnt vmcnt(4) lgkmcnt(4)
    v_mfma_f32_16x16x32_bf16 v[144:147], v[176:179], v[124:127], v[144:147]
    ds_read_b64_tr_b16 v[160:161], v196 offset:40960
    ds_read_b64_tr_b16 v[162:163], v196 offset:43008
    v_lshlrev_b32_e64 v48, 16, v32
    v_and_b32 v49, 0xffff0000, v32
    v_mfma_f32_16x16x32_bf16 v[148:151], v[180:183], v[124:127], v[148:151]
    ds_read_b64_tr_b16 v[164:165], v197 offset:40960
    ds_read_b64_tr_b16 v[166:167], v197 offset:43008
    v_lshlrev_b32 v50, 16, v33
    v_and_b32 v51, 0xffff0000, v33
    s_waitcnt lgkmcnt(4)
    v_mfma_f32_16x16x32_bf16 v[152:155], v[184:187], v[124:127], v[152:155]
    ds_read_b64_tr_b16 v[168:169], v198 offset:40960
    ds_read_b64_tr_b16 v[170:171], v198 offset:43008
    v_lshlrev_b32_e64 v52, 16, v34
    v_and_b32 v53, 0xffff0000, v34
    v_mfma_f32_16x16x32_bf16 v[156:159], v[188:191], v[124:127], v[156:159]
    ds_read_b64_tr_b16 v[172:173], v199 offset:40960
    ds_read_b64_tr_b16 v[174:175], v199 offset:43008
    v_lshlrev_b32_e64 v54, 16, v35
    v_and_b32 v55, 0xffff0000, v35
    s_waitcnt vmcnt(3) lgkmcnt(4)
    v_mfma_f32_16x16x32_bf16 v[144:147], v[160:163], v[128:131], v[144:147]
    ds_read_b64_tr_b16 v[176:177], v196 offset:45056
    ds_read_b64_tr_b16 v[178:179], v196 offset:47104
    v_lshlrev_b32 v56, 16, v36
    v_and_b32 v57, 0xffff0000, v36
    v_mfma_f32_16x16x32_bf16 v[148:151], v[164:167], v[128:131], v[148:151]
    ds_read_b64_tr_b16 v[180:181], v197 offset:45056
    ds_read_b64_tr_b16 v[182:183], v197 offset:47104
    v_lshlrev_b32 v58, 16, v37
    v_and_b32 v59, 0xffff0000, v37
    s_waitcnt lgkmcnt(4)
    v_mfma_f32_16x16x32_bf16 v[152:155], v[168:171], v[128:131], v[152:155]
    ds_read_b64_tr_b16 v[184:185], v198 offset:45056
    ds_read_b64_tr_b16 v[186:187], v198 offset:47104
    v_lshlrev_b32_e64 v60, 16, v38
    v_and_b32 v61, 0xffff0000, v38
    v_mfma_f32_16x16x32_bf16 v[156:159], v[172:175], v[128:131], v[156:159]
    ds_read_b64_tr_b16 v[188:189], v199 offset:45056
    ds_read_b64_tr_b16 v[190:191], v199 offset:47104
    v_lshlrev_b32_e64 v62, 16, v39
    v_and_b32 v63, 0xffff0000, v39
    s_waitcnt vmcnt(2) lgkmcnt(4)
    v_mfma_f32_16x16x32_bf16 v[144:147], v[176:179], v[132:135], v[144:147]
    ds_read_b64_tr_b16 v[160:161], v196 offset:49152
    ds_read_b64_tr_b16 v[162:163], v196 offset:51200
    v_mul_f32 v48, v48, v4
    v_mul_f32_e64 v49, v49, v4
    v_mfma_f32_16x16x32_bf16 v[148:151], v[180:183], v[132:135], v[148:151]
    ds_read_b64_tr_b16 v[164:165], v197 offset:49152
    ds_read_b64_tr_b16 v[166:167], v197 offset:51200
    v_mul_f32 v50, v50, v4
    v_mul_f32_e64 v51, v51, v4
    s_waitcnt lgkmcnt(4)
    v_mfma_f32_16x16x32_bf16 v[152:155], v[184:187], v[132:135], v[152:155]
    ds_read_b64_tr_b16 v[168:169], v198 offset:49152
    ds_read_b64_tr_b16 v[170:171], v198 offset:51200
    v_mul_f32 v52, v52, v4
    v_mul_f32 v53, v53, v4
    v_mfma_f32_16x16x32_bf16 v[156:159], v[188:191], v[132:135], v[156:159]
    ds_read_b64_tr_b16 v[172:173], v199 offset:49152
    ds_read_b64_tr_b16 v[174:175], v199 offset:51200
    v_mul_f32 v54, v54, v4
    v_mul_f32_e64 v55, v55, v4
    s_waitcnt vmcnt(1) lgkmcnt(4)
    v_mfma_f32_16x16x32_bf16 v[144:147], v[160:163], v[136:139], v[144:147]
    ds_read_b64_tr_b16 v[176:177], v196 offset:53248
    ds_read_b64_tr_b16 v[178:179], v196 offset:55296
    v_mul_f32 v56, v56, v4
    v_mul_f32 v57, v57, v4
    v_mfma_f32_16x16x32_bf16 v[148:151], v[164:167], v[136:139], v[148:151]
    ds_read_b64_tr_b16 v[180:181], v197 offset:53248
    ds_read_b64_tr_b16 v[182:183], v197 offset:55296
    v_mul_f32 v58, v58, v4
    v_mul_f32 v59, v59, v4
    s_waitcnt lgkmcnt(4)
    v_mfma_f32_16x16x32_bf16 v[152:155], v[168:171], v[136:139], v[152:155]
    ds_read_b64_tr_b16 v[184:185], v198 offset:53248
    ds_read_b64_tr_b16 v[186:187], v198 offset:55296
    v_mul_f32 v60, v60, v4
    v_mul_f32 v61, v61, v4
    v_mfma_f32_16x16x32_bf16 v[156:159], v[172:175], v[136:139], v[156:159]
    ds_read_b64_tr_b16 v[188:189], v199 offset:53248
    ds_read_b64_tr_b16 v[190:191], v199 offset:55296
    v_mul_f32 v62, v62, v4
    v_mul_f32 v63, v63, v4
    s_waitcnt vmcnt(0) lgkmcnt(4)
    v_mfma_f32_16x16x32_bf16 v[144:147], v[176:179], v[140:143], v[144:147]
    v_mov_b32 v4, v5
    v_mfma_f32_16x16x32_bf16 v[148:151], v[180:183], v[140:143], v[148:151]
    s_waitcnt lgkmcnt(0)
    v_mfma_f32_16x16x32_bf16 v[152:155], v[184:187], v[140:143], v[152:155]
    v_mfma_f32_16x16x32_bf16 v[156:159], v[188:191], v[140:143], v[156:159]
    s_nop 2
    v_pk_fma_f32 v[64:65], v[144:145], v[4:5], v[48:49]
    s_nop 0
    v_pk_fma_f32 v[66:67], v[146:147], v[4:5], v[50:51]
    v_pk_fma_f32 v[68:69], v[148:149], v[4:5], v[52:53]
    v_pk_fma_f32 v[70:71], v[150:151], v[4:5], v[54:55]
    v_pk_fma_f32 v[72:73], v[152:153], v[4:5], v[56:57]
    v_pk_fma_f32 v[74:75], v[154:155], v[4:5], v[58:59]
    v_pk_fma_f32 v[76:77], v[156:157], v[4:5], v[60:61]
    v_pk_fma_f32 v[78:79], v[158:159], v[4:5], v[62:63]
    v_cvt_pk_bf16_f32 v32, v64, v65
    v_cvt_pk_bf16_f32 v33, v66, v67
    v_cvt_pk_bf16_f32 v34, v68, v69
    v_cvt_pk_bf16_f32 v35, v70, v71
    v_cvt_pk_bf16_f32 v36, v72, v73
    v_cvt_pk_bf16_f32 v37, v74, v75
    v_cvt_pk_bf16_f32 v38, v76, v77
    v_cvt_pk_bf16_f32 v39, v78, v79
    v_permlane16_swap_b32 v32, v34
    v_permlane16_swap_b32 v33, v35
    v_permlane16_swap_b32 v36, v38
    v_permlane16_swap_b32 v37, v39
    buffer_store_dwordx4 v[32:35], v10, s[16:19], s36 offen offset:0
    buffer_store_dwordx4 v[36:39], v10, s[16:19], s36 offen offset:64
    s_lshl_b32 s35, s2, 3
    s_add_u32 s35, s35, s3
    s_cmp_lg_u32 s35, 0
    s_cbranch_scc1 L_A_fin
    s_mov_b32 s35, 0xae6000
    v_mov_b32 v1, 0
    s_mov_b64 exec, 1
    buffer_store_dword v28, v1, s[12:15], s35 offen sc1
    s_mov_b64 exec, -1
L_A_fin:
    s_endpgm
L_B:
    v_lshlrev_b32 v2, 4, v0
    v_mov_b32 v22, 163792
    s_lshl_b32 s35, s3, 2
    v_add_u32_e64 v29, s35, v22
    s_mul_i32 s39, s32, 9216
    s_add_u32 s39, s39, 122880
    s_waitcnt lgkmcnt(0)
    s_mul_i32 s4, s4, 0x9E3779B1
    s_add_u32 s4, s4, 0x7F4A7C15
    v_mov_b32 v28, s4
    s_barrier
    s_add_u32 s35, s31, 2
    s_cmp_ge_u32 s35, 7
    s_cselect_b32 s63, 7, 0
    s_sub_u32 s35, s35, s63
    s_lshl_b32 s63, s35, 7
    s_add_u32 s63, s63, s24
    s_add_u32 m0, s25, 16384
    s_mul_i32 s35, s35, 229376
    buffer_load_dwordx4 v6, s[8:11], s63 offen lds
    s_add_u32 m0, s25, 17408
    s_add_u32 s35, s35, s33
    buffer_load_dwordx4 v4, s[8:11], s63 offen lds
    s_add_u32 m0, s34, 32768
    s_nop 0
    buffer_load_dwordx4 v10, s[16:19], s35 offen lds
    s_add_u32 m0, s34, 33792
    s_nop 0
    buffer_load_dwordx4 v11, s[16:19], s35 offen lds
    s_add_u32 m0, s34, 34816
    s_nop 0
    buffer_load_dwordx4 v12, s[16:19], s35 offen lds
    s_add_u32 m0, s34, 35840
    s_nop 0
    buffer_load_dwordx4 v13, s[16:19], s35 offen lds
    v_lshrrev_b32 v18, 2, v0
    v_mul_u32_u24 v18, 3584, v18
    v_lshrrev_b32 v19, 4, v0
    v_and_b32 v19, 2, v19
    v_xor_b32 v19, v19, v0
    v_and_b32_e64 v19, 3, v19
    v_lshl_add_u32 v18, v19, 4, v18
    v_add_u32 v19, 57344, v18
    s_lshl_b32 s38, s29, 8
    s_lshl_b32 s35, s32, 6
    s_add_u32 s38, s38, s35
    s_lshl_b32 s40, s32, 11
    s_lshl_b32 s41, s31, 1
    v_mul_u32_u24 v7, 144, v0
    v_add_u32 v7, s39, v7
    v_lshrrev_b32 v1, 5, v0
    v_lshrrev_b32 v3, 2, v8
    v_lshl_add_u32 v1, v1, 2, v3
    v_mul_u32_u24 v1, 144, v1
    v_and_b32 v3, 1, v9
    v_lshl_add_u32 v1, v3, 5, v1
    v_and_b32 v3, 3, v0
    v_lshl_add_u32 v1, v3, 3, v1
    v_add_u32 v1, s39, v1
    s_barrier
    s_add_u32 s35, s31, 3
    s_cmp_ge_u32 s35, 7
    s_cselect_b32 s63, 7, 0
    s_sub_u32 s35, s35, s63
    s_lshl_b32 s63, s35, 7
    s_add_u32 s63, s63, s24
    s_add_u32 m0, s25, 24576
    s_mul_i32 s35, s35, 229376
    buffer_load_dwordx4 v6, s[8:11], s63 offen lds
    s_add_u32 m0, s25, 25600
    s_add_u32 s35, s35, s33
    buffer_load_dwordx4 v4, s[8:11], s63 offen lds
    s_add_u32 m0, s34, 49152
    s_nop 0
    buffer_load_dwordx4 v10, s[16:19], s35 offen lds
    s_add_u32 m0, s34, 50176
    s_nop 0
    buffer_load_dwordx4 v11, s[16:19], s35 offen lds
    s_add_u32 m0, s34, 51200
    s_nop 0
    buffer_load_dwordx4 v12, s[16:19], s35 offen lds
    s_add_u32 m0, s34, 52224
    s_nop 0
    buffer_load_dwordx4 v13, s[16:19], s35 offen lds
    s_and_b32 s35, s28, 7
    s_lshl_b32 s35, s35, 2
    s_add_u32 s35, s35, s32
    s_mul_i32 s42, s35, 50176
    s_lshl_b32 s35, s29, 8
    s_add_u32 s42, s42, s35
    v_min_u32 v16, 27, v0
    v_lshrrev_b32 v17, 1, v16
    v_mul_u32_u24 v17, 3584, v17
    v_and_b32 v16, 1, v16
    v_lshl_add_u32 v16, v16, 7, v17
    v_lshrrev_b32 v156, 2, v8
    v_lshl_add_u32 v156, v9, 3, v156
    v_lshrrev_b32 v157, 1, v156
    v_and_b32 v157, 7, v157
    v_and_b32 v158, 3, v0
    v_lshrrev_b32 v159, 1, v158
    s_lshl_b32 s35, s32, 1
    v_add_u32 v159, s35, v159
    v_xor_b32 v157, v157, v159
    v_lshlrev_b32 v157, 4, v157
    v_lshl_add_u32 v157, v156, 7, v157
    v_and_b32 v158, 1, v158
    v_lshl_add_u32 v157, v158, 3, v157
    s_add_u32 s35, s29, 7
    s_sub_u32 s35, s35, s31
    s_cmp_ge_u32 s35, 7
    s_cselect_b32 s63, 7, 0
    s_sub_u32 s35, s35, s63
    s_lshl_b32 s35, s35, 13
    s_add_u32 s35, s35, 65536
    v_add_u32 v157, s35, v157
    v_xor_b32_e64 v158, 32, v157
    v_add_u32 v158, 512, v158
    v_lshlrev_b32 v159, 12, v8
    v_lshl_add_u32 v159, v9, 4, v159
    s_lshl_b32 s36, s29, 2
    s_add_u32 s36, s36, s32
    s_lshl_b32 s36, s36, 16
    s_lshl_b32 s35, s28, 7
    s_add_u32 s36, s36, s35
    s_add_u32 s36, s36, 0x700000
    s_lshl_b32 s37, s29, 5
    s_add_u32 s37, s37, s28
    s_lshl_b32 s37, s37, 2
    s_add_u32 s37, s37, s32
    s_lshl_b32 s37, s37, 2
    s_add_u32 s37, s37, 0xae5000
    buffer_load_dword v209, v16, s[16:19], s42 offen
    s_waitcnt vmcnt(7)
    s_barrier
    s_add_u32 s35, s31, 4
    s_cmp_ge_u32 s35, 7
    s_cselect_b32 s63, 7, 0
    s_sub_u32 s35, s35, s63
    s_lshl_b32 s63, s35, 7
    s_add_u32 s63, s63, s24
    s_add_u32 m0, s25, 32768
    s_mul_i32 s35, s35, 229376
    buffer_load_dwordx4 v6, s[8:11], s63 offen lds
    s_add_u32 m0, s25, 33792
    s_add_u32 s35, s35, s33
    buffer_load_dwordx4 v4, s[8:11], s63 offen lds
    s_add_u32 m0, s34, 0
    s_nop 0
    buffer_load_dwordx4 v10, s[16:19], s35 offen lds
    s_add_u32 m0, s34, 1024
    s_nop 0
    buffer_load_dwordx4 v11, s[16:19], s35 offen lds
    s_add_u32 m0, s34, 2048
    s_nop 0
    buffer_load_dwordx4 v12, s[16:19], s35 offen lds
    s_add_u32 m0, s34, 3072
    s_nop 0
    buffer_load_dwordx4 v13, s[16:19], s35 offen lds
    s_waitcnt vmcnt(7)
    s_barrier
    s_add_u32 s35, s31, 5
    s_cmp_ge_u32 s35, 7
    s_cselect_b32 s63, 7, 0
    s_sub_u32 s35, s35, s63
    s_lshl_b32 s63, s35, 7
    s_add_u32 s63, s63, s24
    s_add_u32 m0, s25, 40960
    s_mul_i32 s35, s35, 229376
    buffer_load_dwordx4 v6, s[8:11], s63 offen lds
    s_add_u32 m0, s25, 41984
    s_add_u32 s35, s35, s33
    buffer_load_dwordx4 v4, s[8:11], s63 offen lds
    s_add_u32 m0, s34, 16384
    s_nop 0
    buffer_load_dwordx4 v10, s[16:19], s35 offen lds
    s_add_u32 m0, s34, 17408
    s_nop 0
    buffer_load_dwordx4 v11, s[16:19], s35 offen lds
    s_add_u32 m0, s34, 18432
    s_nop 0
    buffer_load_dwordx4 v12, s[16:19], s35 offen lds
    s_add_u32 m0, s34, 19456
    s_nop 0
    buffer_load_dwordx4 v13, s[16:19], s35 offen lds
    s_waitcnt vmcnt(6)
    s_barrier
    s_add_u32 s35, s31, 6
    s_cmp_ge_u32 s35, 7
    s_cselect_b32 s63, 7, 0
    s_sub_u32 s35, s35, s63
    s_lshl_b32 s63, s35, 7
    s_add_u32 s63, s63, s24
    s_add_u32 m0, s25, 49152
    s_mul_i32 s35, s35, 229376
    buffer_load_dwordx4 v6, s[8:11], s63 offen lds
    s_add_u32 m0, s25, 50176
    s_add_u32 s35, s35, s33
    buffer_load_dwordx4 v4, s[8:11], s63 offen lds
    s_add_u32 m0, s34, 32768
    s_nop 0
    buffer_load_dwordx4 v10, s[16:19], s35 offen lds
    s_add_u32 m0, s34, 33792
    s_nop 0
    buffer_load_dwordx4 v11, s[16:19], s35 offen lds
    s_add_u32 m0, s34, 34816
    s_nop 0
    buffer_load_dwordx4 v12, s[16:19], s35 offen lds
    s_add_u32 m0, s34, 35840
    s_nop 0
    buffer_load_dwordx4 v13, s[16:19], s35 offen lds
    s_mul_i32 s35, s41, 114688
    s_add_u32 s35, s35, s38
    s_add_u32 m0, s40, 49152
    s_add_u32 s41, s41, 1
    buffer_load_dwordx4 v18, s[16:19], s35 offen lds
    s_add_u32 m0, s40, 50176
    s_cmp_eq_u32 s41, 14
    buffer_load_dwordx4 v19, s[16:19], s35 offen lds
    s_cselect_b32 s41, 0, s41
    s_mul_i32 s35, s41, 114688
    s_add_u32 s35, s35, s38
    s_add_u32 m0, s40, 57344
    s_add_u32 s41, s41, 1
    buffer_load_dwordx4 v18, s[16:19], s35 offen lds
    s_add_u32 m0, s40, 58368
    s_cmp_eq_u32 s41, 14
    buffer_load_dwordx4 v19, s[16:19], s35 offen lds
    s_cselect_b32 s41, 0, s41
    s_waitcnt vmcnt(10)
    s_barrier
    s_mul_i32 s35, s41, 114688
    s_add_u32 s35, s35, s38
    s_add_u32 m0, s40, 0
    s_add_u32 s41, s41, 1
    buffer_load_dwordx4 v18, s[16:19], s35 offen lds
    s_add_u32 m0, s40, 1024
    s_cmp_eq_u32 s41, 14
    buffer_load_dwordx4 v19, s[16:19], s35 offen lds
    s_cselect_b32 s41, 0, s41
    s_mul_i32 s35, s41, 114688
    s_add_u32 s35, s35, s38
    s_add_u32 m0, s40, 8192
    s_add_u32 s41, s41, 1
    buffer_load_dwordx4 v18, s[16:19], s35 offen lds
    s_add_u32 m0, s40, 9216
    s_cmp_eq_u32 s41, 14
    buffer_load_dwordx4 v19, s[16:19], s35 offen lds
    s_cselect_b32 s41, 0, s41
    s_waitcnt vmcnt(8)
    s_barrier
    s_mul_i32 s35, s41, 114688
    s_add_u32 s35, s35, s38
    s_add_u32 m0, s40, 16384
    s_add_u32 s41, s41, 1
    buffer_load_dwordx4 v18, s[16:19], s35 offen lds
    s_add_u32 m0, s40, 17408
    s_cmp_eq_u32 s41, 14
    buffer_load_dwordx4 v19, s[16:19], s35 offen lds
    s_cselect_b32 s41, 0, s41
    s_mul_i32 s35, s41, 114688
    s_add_u32 s35, s35, s38
    s_add_u32 m0, s40, 24576
    s_add_u32 s41, s41, 1
    buffer_load_dwordx4 v18, s[16:19], s35 offen lds
    s_add_u32 m0, s40, 25600
    s_cmp_eq_u32 s41, 14
    buffer_load_dwordx4 v19, s[16:19], s35 offen lds
    s_cselect_b32 s41, 0, s41
    ds_read_b64_tr_b16 v[160:161], v157 offset:0
    ds_read_b64_tr_b16 v[162:163], v158 offset:0
    ds_read_b64_tr_b16 v[164:165], v157 offset:4096
    ds_read_b64_tr_b16 v[166:167], v158 offset:4096
    s_waitcnt lgkmcnt(0)
    s_barrier
    s_mul_i32 s35, s41, 114688
    s_add_u32 s35, s35, s38
    s_add_u32 m0, s40, 32768
    s_add_u32 s41, s41, 1
    buffer_load_dwordx4 v18, s[16:19], s35 offen lds
    s_add_u32 m0, s40, 33792
    s_cmp_eq_u32 s41, 14
    buffer_load_dwordx4 v19, s[16:19], s35 offen lds
    s_cselect_b32 s41, 0, s41
    s_mul_i32 s35, s41, 114688
    s_add_u32 s35, s35, s38
    s_add_u32 m0, s40, 40960
    s_add_u32 s41, s41, 1
    buffer_load_dwordx4 v18, s[16:19], s35 offen lds
    s_add_u32 m0, s40, 41984
    s_cmp_eq_u32 s41, 14
    buffer_load_dwordx4 v19, s[16:19], s35 offen lds
    s_cselect_b32 s41, 0, s41
    buffer_store_dwordx4 v[160:163], v159, s[12:15], s36 offen offset:0 sc1
    buffer_store_dwordx4 v[164:167], v159, s[12:15], s36 offen offset:64 sc1
    v_lshlrev_b32 v208, 16, v208
    v_mul_f32 v208, 0x3fb8aa3b, v208
    v_exp_f32_e64 v208, v208
    s_nop 0
    v_cvt_pk_bf16_f32 v208, v208, v208
    v_lshlrev_b32 v208, 16, v208
    v_lshlrev_b32 v200, 16, v200
    v_mul_f32 v200, 0x3fb8aa3b, v200
    v_exp_f32 v200, v200
    v_lshlrev_b32 v201, 16, v201
    v_lshlrev_b32 v202, 16, v202
    v_lshlrev_b32 v203, 16, v203
    v_cvt_pk_bf16_f32 v200, v200, v200
    v_mul_f32 v201, v201, v208
    v_lshlrev_b32 v200, 16, v200
    v_mul_f32 v201, 0.15915494, v201
    v_mul_f32 v200, v200, v208
    v_add_f32 v60, v208, v208
    v_mul_f32 v200, 0xbfb8aa3b, v200
    v_mul_f32 v56, v202, v60
    v_mul_f32_e64 v57, v203, v60
    v_mul_f32 v60, 0x41000000, v200
    v_mul_f32 v61, 0x41000000, v201
    v_exp_f32 v60, v60
    v_fract_f32 v61, v61
    v_cos_f32 v35, v61
    s_waitcnt vmcnt(2)
    v_mov_b32_e64 v23, 1
    ds_write_b32 v29, v23
    v_sin_f32 v36, v61
    v_mul_f32 v35, v35, v60
    v_mul_f32 v36, v36, v60
    v_sub_f32 v37, 0, v36
    v_mul_f32 v60, 0x3f800000, v200
    v_mul_f32 v61, 0x3f800000, v201
    v_exp_f32 v60, v60
    v_fract_f32 v61, v61
    v_cos_f32 v32, v61
    v_sin_f32 v33, v61
    v_mul_f32 v32, v32, v60
    v_mul_f32 v33, v33, v60
    v_sub_f32_e64 v34, 0, v33
    v_mul_f32 v60, 0x43800000, v200
    v_mul_f32 v61, 0x43800000, v201
    v_exp_f32 v60, v60
    v_fract_f32 v61, v61
    v_cos_f32 v38, v61
    v_sin_f32 v39, v61
    v_mul_f32 v38, v38, v60
    v_mul_f32 v39, v39, v60
    v_sub_f32 v40, 0, v39
    v_mov_b32 v128, 1.0
    v_mov_b32 v129, 0
    v_mov_b32 v130, v35
    v_mov_b32 v131, v36
    v_mul_f32 v132, v130, v35
    v_mul_f32 v133, v131, v35
    v_fmac_f32 v132, v131, v37
    v_fmac_f32 v133, v130, v36
    v_mul_f32 v134, v132, v35
    v_mul_f32 v135, v133, v35
    v_fmac_f32 v134, v133, v37
    v_fmac_f32 v135, v132, v36
    v_mul_f32 v136, v134, v35
    v_mul_f32 v137, v135, v35
    v_fmac_f32 v136, v135, v37
    v_fmac_f32 v137, v134, v36
    v_mul_f32 v138, v136, v35
    v_mul_f32 v139, v137, v35
    v_fmac_f32 v138, v137, v37
    v_fmac_f32 v139, v136, v36
    v_mul_f32 v140, v138, v35
    v_mul_f32 v141, v139, v35
    v_fmac_f32 v140, v139, v37
    v_fmac_f32 v141, v138, v36
    v_mul_f32 v142, v140, v35
    v_mul_f32 v143, v141, v35
    v_fmac_f32 v142, v141, v37
    v_fmac_f32_e64 v143, v140, v36
    v_cvt_pk_bf16_f32 v48, v128, v130
    v_cvt_pk_bf16_f32 v49, v132, v134
    v_cvt_pk_bf16_f32 v50, v136, v138
    v_cvt_pk_bf16_f32 v51, v140, v142
    ds_write_b128 v7, v[48:51] offset:0
    v_cvt_pk_bf16_f32 v52, -v129, -v131
    v_cvt_pk_bf16_f32 v53, -v133, -v135
    v_cvt_pk_bf16_f32 v54, -v137, -v139
    v_cvt_pk_bf16_f32 v55, -v141, -v143
    s_waitcnt vmcnt(0)
    v_mov_b32 v10, 0
    s_mov_b64 exec, 1
    buffer_store_dword v28, v10, s[12:15], s37 offen sc1
    s_mov_b64 exec, -1
    ds_write_b128 v7, v[52:55] offset:64
    v_mul_f32 v128, v142, v35
    v_mul_f32 v129, v143, v35
    v_fmac_f32 v128, v143, v37
    v_fmac_f32 v129, v142, v36
    v_mul_f32 v130, v128, v35
    v_mul_f32 v131, v129, v35
    v_fmac_f32 v130, v129, v37
    v_fmac_f32 v131, v128, v36
    v_mul_f32 v132, v130, v35
    v_mul_f32 v133, v131, v35
    v_fmac_f32 v132, v131, v37
    v_fmac_f32 v133, v130, v36
    v_mul_f32 v134, v132, v35
    v_mul_f32 v135, v133, v35
    v_fmac_f32 v134, v133, v37
    v_fmac_f32 v135, v132, v36
    v_mul_f32 v136, v134, v35
    v_mul_f32 v137, v135, v35
    v_fmac_f32 v136, v135, v37
    v_fmac_f32 v137, v134, v36
    v_mul_f32 v138, v136, v35
    v_mul_f32 v139, v137, v35
    v_fmac_f32 v138, v137, v37
    v_fmac_f32 v139, v136, v36
    v_mul_f32 v140, v138, v35
    v_mul_f32 v141, v139, v35
    v_fmac_f32 v140, v139, v37
    v_fmac_f32 v141, v138, v36
    v_mul_f32 v142, v140, v35
    v_mul_f32 v143, v141, v35
    v_fmac_f32 v142, v141, v37
    v_fmac_f32 v143, v140, v36
    v_cvt_pk_bf16_f32 v48, v128, v130
    v_cvt_pk_bf16_f32 v49, v132, v134
    v_cvt_pk_bf16_f32 v50, v136, v138
    v_cvt_pk_bf16_f32 v51, v140, v142
    ds_write_b128 v7, v[48:51] offset:16
    v_cvt_pk_bf16_f32 v52, -v129, -v131
    v_cvt_pk_bf16_f32 v53, -v133, -v135
    v_cvt_pk_bf16_f32 v54, -v137, -v139
    v_cvt_pk_bf16_f32 v55, -v141, -v143
    ds_write_b128 v7, v[52:55] offset:80
    v_mul_f32 v128, v142, v35
    v_mul_f32 v129, v143, v35
    v_fmac_f32 v128, v143, v37
    v_fmac_f32 v129, v142, v36
    v_mul_f32 v130, v128, v35
    v_mul_f32 v131, v129, v35
    v_fmac_f32 v130, v129, v37
    v_fmac_f32 v131, v128, v36
    v_mul_f32 v132, v130, v35
    v_mul_f32 v133, v131, v35
    v_fmac_f32 v132, v131, v37
    v_fmac_f32 v133, v130, v36
    v_mul_f32 v134, v132, v35
    v_mul_f32 v135, v133, v35
    v_fmac_f32 v134, v133, v37
    v_fmac_f32 v135, v132, v36
    v_mul_f32 v136, v134, v35
    v_mul_f32 v137, v135, v35
    v_fmac_f32 v136, v135, v37
    v_fmac_f32 v137, v134, v36
    v_mul_f32 v138, v136, v35
    v_mul_f32 v139, v137, v35
    v_fmac_f32 v138, v137, v37
    v_fmac_f32 v139, v136, v36
    v_mul_f32 v140, v138, v35
    v_mul_f32 v141, v139, v35
    v_fmac_f32 v140, v139, v37
    v_fmac_f32 v141, v138, v36
    v_mul_f32 v142, v140, v35
    v_mul_f32 v143, v141, v35
    v_fmac_f32 v142, v141, v37
    v_fmac_f32 v143, v140, v36
    v_cvt_pk_bf16_f32 v48, v128, v130
    v_cvt_pk_bf16_f32 v49, v132, v134
    v_cvt_pk_bf16_f32 v50, v136, v138
    v_cvt_pk_bf16_f32 v51, v140, v142
    ds_write_b128 v7, v[48:51] offset:32
    v_cvt_pk_bf16_f32 v52, -v129, -v131
    v_cvt_pk_bf16_f32 v53, -v133, -v135
    v_cvt_pk_bf16_f32 v54, -v137, -v139
    v_cvt_pk_bf16_f32 v55, -v141, -v143
    ds_write_b128 v7, v[52:55] offset:96
    v_mul_f32 v128, v142, v35
    v_mul_f32 v129, v143, v35
    v_fmac_f32 v128, v143, v37
    v_fmac_f32 v129, v142, v36
    v_mul_f32 v130, v128, v35
    v_mul_f32 v131, v129, v35
    v_fmac_f32 v130, v129, v37
    v_fmac_f32 v131, v128, v36
    v_mul_f32 v132, v130, v35
    v_mul_f32 v133, v131, v35
    v_fmac_f32 v132, v131, v37
    v_fmac_f32 v133, v130, v36
    v_mul_f32 v134, v132, v35
    v_mul_f32 v135, v133, v35
    v_fmac_f32 v134, v133, v37
    v_fmac_f32 v135, v132, v36
    v_mul_f32 v136, v134, v35
    v_mul_f32 v137, v135, v35
    v_fmac_f32 v136, v135, v37
    v_fmac_f32 v137, v134, v36
    v_mul_f32 v138, v136, v35
    v_mul_f32 v139, v137, v35
    v_fmac_f32 v138, v137, v37
    v_fmac_f32 v139, v136, v36
    v_mul_f32 v140, v138, v35
    v_mul_f32 v141, v139, v35
    v_fmac_f32 v140, v139, v37
    v_fmac_f32 v141, v138, v36
    v_mul_f32 v142, v140, v35
    v_mul_f32 v143, v141, v35
    v_fmac_f32 v142, v141, v37
    v_fmac_f32 v143, v140, v36
    v_cvt_pk_bf16_f32 v48, v128, v130
    v_cvt_pk_bf16_f32 v49, v132, v134
    v_cvt_pk_bf16_f32 v50, v136, v138
    v_cvt_pk_bf16_f32 v51, v140, v142
    ds_write_b128 v7, v[48:51] offset:48
    v_cvt_pk_bf16_f32 v52, -v129, -v131
    v_cvt_pk_bf16_f32 v53, -v133, -v135
    v_cvt_pk_bf16_f32 v54, -v137, -v139
    v_cvt_pk_bf16_f32 v55, -v141, -v143
    ds_write_b128 v7, v[52:55] offset:112
    v_mul_f32 v41, v32, v32
    v_mul_f32 v42, v33, v32
    v_fmac_f32 v41, v33, v34
    v_fmac_f32 v42, v32, v33
    v_sub_f32 v43, 0, v42
    v_mul_f32 v44, v41, v41
    v_mul_f32 v45, v42, v41
    v_fmac_f32 v44, v42, v43
    v_fmac_f32 v45, v41, v42
    v_sub_f32 v46, 0, v45
    s_waitcnt lgkmcnt(0)
    ds_read_b64_tr_b16 v[64:65], v1 offset:0
    ds_read_b64_tr_b16 v[66:67], v1 offset:64
    ds_read_b64_tr_b16 v[68:69], v1 offset:1152
    s_nop 0
    ds_read_b64_tr_b16 v[70:71], v1 offset:1216
    ds_read_b64_tr_b16 v[72:73], v1 offset:2304
    ds_read_b64_tr_b16 v[74:75], v1 offset:2368
    ds_read_b64_tr_b16 v[76:77], v1 offset:3456
    ds_read_b64_tr_b16 v[78:79], v1 offset:3520
    ds_read_b64_tr_b16 v[80:81], v1 offset:4608
    ds_read_b64_tr_b16 v[82:83], v1 offset:4672
    ds_read_b64_tr_b16 v[84:85], v1 offset:5760
    ds_read_b64_tr_b16 v[86:87], v1 offset:5824
    ds_read_b64_tr_b16 v[88:89], v1 offset:6912
    ds_read_b64_tr_b16 v[90:91], v1 offset:6976
    ds_read_b64_tr_b16 v[92:93], v1 offset:8064
    ds_read_b64_tr_b16 v[94:95], v1 offset:8128
    v_mul_f32 v130, v56, v32
    v_mul_f32 v131, v57, v32
    v_fmac_f32 v130, v57, v34
    v_fmac_f32 v131, v56, v33
    v_mul_f32 v132, v130, v32
    v_mul_f32 v133, v131, v32
    v_fmac_f32 v132, v131, v34
    v_fmac_f32 v133, v130, v33
    v_mul_f32 v134, v132, v32
    v_mul_f32 v135, v133, v32
    v_fmac_f32 v134, v133, v34
    v_fmac_f32 v135, v132, v33
    v_mul_f32 v136, v134, v32
    v_mul_f32 v137, v135, v32
    v_fmac_f32 v136, v135, v34
    v_fmac_f32 v137, v134, v33
    v_mul_f32 v138, v136, v32
    v_mul_f32 v139, v137, v32
    v_fmac_f32 v138, v137, v34
    v_fmac_f32 v139, v136, v33
    v_mul_f32 v140, v138, v32
    v_mul_f32 v141, v139, v32
    v_fmac_f32 v140, v139, v34
    v_fmac_f32 v141, v138, v33
    v_mul_f32 v142, v140, v32
    v_mul_f32 v143, v141, v32
    v_fmac_f32 v142, v141, v34
    v_fmac_f32_e64 v143, v140, v33
    s_waitcnt lgkmcnt(0)
    v_cvt_pk_bf16_f32 v48, v56, v130
    v_cvt_pk_bf16_f32 v49, v132, v134
    v_cvt_pk_bf16_f32 v50, v136, v138
    v_cvt_pk_bf16_f32 v51, v140, v142
    ds_write_b128 v7, v[48:51] offset:0
    v_cvt_pk_bf16_f32 v52, v57, v131
    v_cvt_pk_bf16_f32 v53, v133, v135
    v_cvt_pk_bf16_f32 v54, v137, v139
    v_cvt_pk_bf16_f32 v55, v141, v143
    ds_write_b128 v7, v[52:55] offset:64
    v_mul_f32 v58, v56, v38
    v_mul_f32 v59, v57, v38
    v_fmac_f32 v58, v57, v40
    v_fmac_f32 v59, v56, v39
    v_mul_f32 v130, v58, v41
    v_mul_f32 v131, v59, v41
    v_fmac_f32 v130, v59, v43
    v_fmac_f32 v131, v58, v42
    v_mul_f32 v132, v130, v41
    v_mul_f32 v133, v131, v41
    v_fmac_f32 v132, v131, v43
    v_fmac_f32 v133, v130, v42
    v_mul_f32 v134, v132, v41
    v_mul_f32 v135, v133, v41
    v_fmac_f32 v134, v133, v43
    v_fmac_f32 v135, v132, v42
    v_mul_f32 v136, v134, v41
    v_mul_f32 v137, v135, v41
    v_fmac_f32 v136, v135, v43
    v_fmac_f32 v137, v134, v42
    v_cvt_pk_bf16_f32 v48, v58, v130
    v_cvt_pk_bf16_f32 v49, v132, v132
    v_cvt_pk_bf16_f32 v50, v132, v134
    v_cvt_pk_bf16_f32 v51, v136, v136
    ds_write_b128 v7, v[48:51] offset:16
    v_cvt_pk_bf16_f32 v52, v59, v131
    v_cvt_pk_bf16_f32 v53, v133, v133
    v_cvt_pk_bf16_f32 v54, v133, v135
    v_cvt_pk_bf16_f32 v55, v137, v137
    ds_write_b128 v7, v[52:55] offset:80
    v_mul_f32 v56, v58, v38
    v_mul_f32 v57, v59, v38
    v_fmac_f32 v56, v59, v40
    v_fmac_f32 v57, v58, v39
    v_mul_f32 v128, v56, v44
    v_mul_f32 v129, v57, v44
    v_fmac_f32 v128, v57, v46
    v_fmac_f32 v129, v56, v45
    v_mul_f32 v130, v128, v44
    v_mul_f32 v131, v129, v44
    v_fmac_f32 v130, v129, v46
    v_fmac_f32 v131, v128, v45
    v_mul_f32 v58, v56, v38
    v_mul_f32 v59, v57, v38
    v_fmac_f32 v58, v57, v40
    v_fmac_f32 v59, v56, v39
    v_mul_f32 v132, v58, v44
    v_mul_f32 v133, v59, v44
    v_fmac_f32 v132, v59, v46
    v_fmac_f32 v133, v58, v45
    v_mul_f32 v134, v132, v44
    v_mul_f32 v135, v133, v44
    v_fmac_f32 v134, v133, v46
    v_fmac_f32 v135, v132, v45
    v_cvt_pk_bf16_f32 v48, v56, v128
    v_cvt_pk_bf16_f32 v49, v58, v132
    v_cvt_pk_bf16_f32 v50, v128, v130
    v_cvt_pk_bf16_f32 v51, v132, v134
    ds_write_b128 v7, v[48:51] offset:32
    v_cvt_pk_bf16_f32 v52, v57, v129
    v_cvt_pk_bf16_f32 v53, v59, v133
    v_cvt_pk_bf16_f32 v54, v129, v131
    v_cvt_pk_bf16_f32 v55, v133, v135
    ds_write_b128 v7, v[52:55] offset:96
    v_mul_f32 v128, v58, v38
    v_mul_f32 v129, v59, v38
    v_fmac_f32 v128, v59, v40
    v_fmac_f32 v129, v58, v39
    v_mul_f32 v130, v128, v38
    v_mul_f32 v131, v129, v38
    v_fmac_f32 v130, v129, v40
    v_fmac_f32 v131, v128, v39
    v_mul_f32 v132, v130, v38
    v_mul_f32 v133, v131, v38
    v_fmac_f32 v132, v131, v40
    v_fmac_f32 v133, v130, v39
    v_mul_f32 v134, v132, v38
    v_mul_f32 v135, v133, v38
    v_fmac_f32 v134, v133, v40
    v_fmac_f32 v135, v132, v39
    v_mul_f32 v136, v128, v35
    v_mul_f32 v137, v129, v35
    v_fmac_f32 v136, v129, v37
    v_fmac_f32 v137, v128, v36
    v_mul_f32 v138, v130, v35
    v_mul_f32 v139, v131, v35
    v_fmac_f32 v138, v131, v37
    v_fmac_f32 v139, v130, v36
    v_mul_f32 v140, v132, v35
    v_mul_f32 v141, v133, v35
    v_fmac_f32 v140, v133, v37
    v_fmac_f32 v141, v132, v36
    v_mul_f32 v142, v134, v35
    v_mul_f32 v143, v135, v35
    v_fmac_f32 v142, v135, v37
    v_fmac_f32 v143, v134, v36
    v_cvt_pk_bf16_f32 v48, v128, v130
    v_cvt_pk_bf16_f32 v49, v132, v134
    v_cvt_pk_bf16_f32 v50, v136, v138
    v_cvt_pk_bf16_f32 v51, v140, v142
    ds_write_b128 v7, v[48:51] offset:48
    v_cvt_pk_bf16_f32 v52, v129, v131
    v_cvt_pk_bf16_f32 v53, v133, v135
    v_cvt_pk_bf16_f32 v54, v137, v139
    v_cvt_pk_bf16_f32 v55, v141, v143
    ds_write_b128 v7, v[52:55] offset:112
    s_waitcnt lgkmcnt(0)
    ds_read_b64_tr_b16 v[96:97], v1 offset:0
    ds_read_b64_tr_b16 v[98:99], v1 offset:64
    ds_read_b64_tr_b16 v[100:101], v1 offset:1152
    s_lshr_b32 s36, s20, 6
    s_lshl_b32 s36, s36, 9
    s_add_u32 s36, s36, 0xae5000
    v_lshlrev_b32 v5, 3, v0
    buffer_load_dwordx2 v[176:177], v5, s[12:15], s36 offen sc1
    s_lshl_b32 s23, s20, 12
    s_add_u32 s44, s12, 0x700000
    s_addc_u32 s45, s13, 0
    s_add_u32 s44, s44, s23
    s_addc_u32 s45, s45, 0
    s_mov_b32 s46, 4096
    s_mov_b32 s47, 0x20000
    v_add_u32 v180, 0, v0
    v_mul_u32_u24 v6, 3856, v180
    v_lshrrev_b32 v6, 16, v6
    v_sub_u32 v180, v180, v6
    v_lshlrev_b32 v180, 4, v180
    v_add_u32 v180, -16, v180
    v_add_u32 v181, 64, v0
    v_mul_u32_u24 v6, 3856, v181
    v_lshrrev_b32 v6, 16, v6
    v_sub_u32 v181, v181, v6
    v_lshlrev_b32 v181, 4, v181
    v_add_u32 v181, -16, v181
    v_add_u32 v182, 128, v0
    v_mul_u32_u24 v6, 3856, v182
    v_lshrrev_b32 v6, 16, v6
    v_sub_u32 v182, v182, v6
    v_lshlrev_b32 v182, 4, v182
    v_add_u32 v182, -16, v182
    v_add_u32 v183, 192, v0
    v_mul_u32_u24 v6, 3856, v183
    v_lshrrev_b32 v6, 16, v6
    v_sub_u32 v183, v183, v6
    v_lshlrev_b32 v183, 4, v183
    v_add_u32 v183, -16, v183
    v_add_u32 v184, 256, v0
    v_mul_u32_u24 v6, 3856, v184
    v_lshrrev_b32 v6, 16, v6
    v_sub_u32 v184, v184, v6
    v_lshlrev_b32 v184, 4, v184
    v_add_u32 v184, -16, v184
    v_mul_u32_u24 v6, 272, v8
    s_lshl_b32 s35, s22, 3
    s_add_u32 s35, s35, s39
    v_lshl_add_u32 v185, v9, 4, v6
    v_add_u32 v185, s35, v185
    v_lshl_add_u32 v186, v9, 6, v6
    v_add_u32 v186, s35, v186
    ds_read_b64_tr_b16 v[102:103], v1 offset:1216
    ds_read_b64_tr_b16 v[104:105], v1 offset:2304
    ds_read_b64_tr_b16 v[106:107], v1 offset:2368
    ds_read_b64_tr_b16 v[108:109], v1 offset:3456
    ds_read_b64_tr_b16 v[110:111], v1 offset:3520
    ds_read_b64_tr_b16 v[112:113], v1 offset:4608
    ds_read_b64_tr_b16 v[114:115], v1 offset:4672
    ds_read_b64_tr_b16 v[116:117], v1 offset:5760
    ds_read_b64_tr_b16 v[118:119], v1 offset:5824
    ds_read_b64_tr_b16 v[120:121], v1 offset:6912
    ds_read_b64_tr_b16 v[122:123], v1 offset:6976
    ds_read_b64_tr_b16 v[124:125], v1 offset:8064
    ds_read_b64_tr_b16 v[126:127], v1 offset:8128
    s_waitcnt lgkmcnt(14)
    v_mfma_f32_32x32x16_bf16 v[232:247], v[96:99], v[64:67], 0
    s_waitcnt lgkmcnt(12)
    v_mfma_f32_32x32x16_bf16 v[232:247], v[100:103], v[68:71], v[232:247]
    s_waitcnt lgkmcnt(10)
    v_mfma_f32_32x32x16_bf16 v[232:247], v[104:107], v[72:75], v[232:247]
    s_waitcnt lgkmcnt(8)
    v_mfma_f32_32x32x16_bf16 v[232:247], v[108:111], v[76:79], v[232:247]
    s_waitcnt lgkmcnt(6)
    v_mfma_f32_32x32x16_bf16 v[232:247], v[112:115], v[80:83], v[232:247]
    s_waitcnt lgkmcnt(4)
    v_mfma_f32_32x32x16_bf16 v[232:247], v[116:119], v[84:87], v[232:247]
    s_waitcnt lgkmcnt(2)
    v_mfma_f32_32x32x16_bf16 v[232:247], v[120:123], v[88:91], v[232:247]
    s_waitcnt lgkmcnt(0)
    v_mfma_f32_32x32x16_bf16 v[232:247], v[124:127], v[92:95], v[232:247]
    s_mov_b32 s62, 65536
    s_waitcnt vmcnt(0)
    s_branch L_pfu_chk
L_pfu:
    buffer_load_dwordx2 v[176:177], v5, s[12:15], s36 offen sc1
    s_waitcnt vmcnt(0)
L_pfu_chk:
    v_cmp_ne_u32 vcc, v28, v176
    v_cmp_ne_u32 s[54:55], v28, v177
    s_or_b64 vcc, vcc, s[54:55]
    s_cbranch_vccz L_pfu_ok
    s_sleep 2
    s_sub_u32 s62, s62, 1
    s_cbranch_scc0 L_pfu
L_pfu_ok:
    s_add_u32 m0, s39, 0
    s_nop 0
    buffer_load_dwordx4 v180, s[44:47], 0 offen sc1 lds
    s_add_u32 m0, s39, 1024
    s_nop 0
    buffer_load_dwordx4 v181, s[44:47], 0 offen sc1 lds
    s_add_u32 m0, s39, 2048
    s_nop 0
    buffer_load_dwordx4 v182, s[44:47], 0 offen sc1 lds
    s_add_u32 m0, s39, 3072
    s_nop 0
    buffer_load_dwordx4 v183, s[44:47], 0 offen sc1 lds
    s_add_u32 m0, s39, 4096
    s_mov_b64 exec, 0xffff
    buffer_load_dwordx4 v184, s[44:47], 0 offen sc1 lds
    s_mov_b64 exec, -1
    v_lshlrev_b32 v204, 16, v204
    v_mul_f32 v204, 0x3fb8aa3b, v204
    v_exp_f32 v204, v204
    v_lshlrev_b32 v205, 16, v205
    v_lshlrev_b32 v206, 16, v206
    v_lshlrev_b32 v207, 16, v207
    v_cvt_pk_bf16_f32 v204, v204, v204
    v_mul_f32 v205, v205, v208
    v_lshlrev_b32 v204, 16, v204
    v_mul_f32 v205, 0.15915494, v205
    v_mul_f32 v204, v204, v208
    v_add_f32 v60, v208, v208
    v_mul_f32 v204, 0xbfb8aa3b, v204
    v_mul_f32 v56, v206, v60
    v_mul_f32 v57, v207, v60
    v_mul_f32 v60, 0x41000000, v204
    v_mul_f32 v61, 0x41000000, v205
    v_exp_f32 v60, v60
    v_fract_f32 v61, v61
    v_cos_f32 v35, v61
    v_sin_f32 v36, v61
    v_mul_f32 v35, v35, v60
    v_mul_f32 v36, v36, v60
    v_sub_f32 v37, 0, v36
    v_mul_f32 v60, 0x3f800000, v204
    v_mul_f32 v61, 0x3f800000, v205
    v_exp_f32 v60, v60
    v_fract_f32 v61, v61
    v_cos_f32 v32, v61
    v_sin_f32 v33, v61
    v_mul_f32 v32, v32, v60
    v_mul_f32 v33, v33, v60
    v_sub_f32_e64 v34, 0, v33
    v_mul_f32 v60, 0x43800000, v204
    v_mul_f32 v61, 0x43800000, v205
    v_exp_f32 v60, v60
    v_fract_f32 v61, v61
    v_cos_f32 v38, v61
    v_sin_f32 v39, v61
    v_mul_f32 v38, v38, v60
    v_mul_f32 v39, v39, v60
    v_sub_f32 v40, 0, v39
    v_mov_b32 v128, 1.0
    v_mov_b32 v129, 0
    v_mov_b32 v130, v35
    v_mov_b32 v131, v36
    v_mul_f32 v132, v130, v35
    v_mul_f32 v133, v131, v35
    v_fmac_f32 v132, v131, v37
    v_fmac_f32 v133, v130, v36
    v_mul_f32 v134, v132, v35
    v_mul_f32 v135, v133, v35
    v_fmac_f32 v134, v133, v37
    v_fmac_f32 v135, v132, v36
    v_mul_f32 v136, v134, v35
    v_mul_f32 v137, v135, v35
    v_fmac_f32 v136, v135, v37
    v_fmac_f32 v137, v134, v36
    v_mul_f32 v138, v136, v35
    v_mul_f32 v139, v137, v35
    v_fmac_f32 v138, v137, v37
    v_fmac_f32 v139, v136, v36
    v_mul_f32 v140, v138, v35
    v_mul_f32 v141, v139, v35
    v_fmac_f32 v140, v139, v37
    v_fmac_f32 v141, v138, v36
    v_mul_f32 v142, v140, v35
    v_mul_f32 v143, v141, v35
    v_fmac_f32 v142, v141, v37
    v_fmac_f32 v143, v140, v36
    s_waitcnt vmcnt(0)
    ds_read_b64 v[144:145], v185 offset:0
    ds_read_b64 v[146:147], v185 offset:8
    ds_read_b64 v[148:149], v185 offset:16
    ds_read_b64 v[150:151], v185 offset:64
    ds_read_b64 v[152:153], v185 offset:72
    ds_read_b64 v[154:155], v185 offset:80
    ds_read_b64 v[156:157], v185 offset:128
    ds_read_b64 v[158:159], v185 offset:136
    ds_read_b64 v[160:161], v185 offset:144
    ds_read_b64 v[162:163], v185 offset:192
    ds_read_b64 v[164:165], v185 offset:200
    ds_read_b64 v[166:167], v185 offset:208
    s_waitcnt lgkmcnt(8)
    ds_read_b64 v[168:169], v186 offset:16
    ds_read_b64 v[170:171], v186 offset:32
    ds_read_b64 v[172:173], v186 offset:48
    ds_read_b64 v[174:175], v186 offset:64
    s_waitcnt lgkmcnt(0)
    v_cvt_pk_bf16_f32 v48, v128, v130
    v_cvt_pk_bf16_f32 v49, v132, v134
    v_cvt_pk_bf16_f32 v50, v136, v138
    v_cvt_pk_bf16_f32 v51, v140, v142
    ds_write_b128 v7, v[48:51] offset:0
    v_cvt_pk_bf16_f32 v52, -v129, -v131
    v_cvt_pk_bf16_f32 v53, -v133, -v135
    v_cvt_pk_bf16_f32 v54, -v137, -v139
    v_cvt_pk_bf16_f32 v55, -v141, -v143
    ds_write_b128 v7, v[52:55] offset:64
    v_mul_f32 v128, v142, v35
    v_mul_f32 v129, v143, v35
    v_fmac_f32 v128, v143, v37
    v_fmac_f32 v129, v142, v36
    v_mul_f32 v130, v128, v35
    v_mul_f32 v131, v129, v35
    v_fmac_f32 v130, v129, v37
    v_fmac_f32 v131, v128, v36
    v_mul_f32 v132, v130, v35
    v_mul_f32 v133, v131, v35
    v_fmac_f32 v132, v131, v37
    v_fmac_f32 v133, v130, v36
    v_mul_f32 v134, v132, v35
    v_mul_f32 v135, v133, v35
    v_fmac_f32 v134, v133, v37
    v_fmac_f32 v135, v132, v36
    v_mul_f32 v136, v134, v35
    v_mul_f32 v137, v135, v35
    v_fmac_f32 v136, v135, v37
    v_fmac_f32 v137, v134, v36
    v_mul_f32 v138, v136, v35
    v_mul_f32 v139, v137, v35
    v_fmac_f32 v138, v137, v37
    v_fmac_f32 v139, v136, v36
    v_mul_f32 v140, v138, v35
    v_mul_f32 v141, v139, v35
    v_fmac_f32 v140, v139, v37
    v_fmac_f32 v141, v138, v36
    v_mul_f32 v142, v140, v35
    v_mul_f32 v143, v141, v35
    v_fmac_f32 v142, v141, v37
    v_fmac_f32 v143, v140, v36
    v_cvt_pk_bf16_f32 v48, v128, v130
    v_cvt_pk_bf16_f32 v49, v132, v134
    v_cvt_pk_bf16_f32 v50, v136, v138
    v_cvt_pk_bf16_f32 v51, v140, v142
    ds_write_b128 v7, v[48:51] offset:16
    v_cvt_pk_bf16_f32 v52, -v129, -v131
    v_cvt_pk_bf16_f32 v53, -v133, -v135
    v_cvt_pk_bf16_f32 v54, -v137, -v139
    v_cvt_pk_bf16_f32 v55, -v141, -v143
    ds_write_b128 v7, v[52:55] offset:80
    v_mul_f32 v128, v142, v35
    v_mul_f32 v129, v143, v35
    v_fmac_f32 v128, v143, v37
    v_fmac_f32 v129, v142, v36
    v_mul_f32 v130, v128, v35
    v_mul_f32 v131, v129, v35
    v_fmac_f32 v130, v129, v37
    v_fmac_f32 v131, v128, v36
    v_mul_f32 v132, v130, v35
    v_mul_f32 v133, v131, v35
    v_fmac_f32 v132, v131, v37
    v_fmac_f32 v133, v130, v36
    v_mul_f32 v134, v132, v35
    v_mul_f32 v135, v133, v35
    v_fmac_f32 v134, v133, v37
    v_fmac_f32 v135, v132, v36
    v_mul_f32 v136, v134, v35
    v_mul_f32 v137, v135, v35
    v_fmac_f32 v136, v135, v37
    v_fmac_f32 v137, v134, v36
    v_mul_f32 v138, v136, v35
    v_mul_f32 v139, v137, v35
    v_fmac_f32 v138, v137, v37
    v_fmac_f32 v139, v136, v36
    v_mul_f32 v140, v138, v35
    v_mul_f32 v141, v139, v35
    v_fmac_f32 v140, v139, v37
    v_fmac_f32 v141, v138, v36
    v_mul_f32 v142, v140, v35
    v_mul_f32 v143, v141, v35
    v_fmac_f32 v142, v141, v37
    v_fmac_f32 v143, v140, v36
    v_cvt_pk_bf16_f32 v48, v128, v130
    v_cvt_pk_bf16_f32 v49, v132, v134
    v_cvt_pk_bf16_f32 v50, v136, v138
    v_cvt_pk_bf16_f32 v51, v140, v142
    ds_write_b128 v7, v[48:51] offset:32
    v_cvt_pk_bf16_f32 v52, -v129, -v131
    v_cvt_pk_bf16_f32 v53, -v133, -v135
    v_cvt_pk_bf16_f32 v54, -v137, -v139
    v_cvt_pk_bf16_f32 v55, -v141, -v143
    ds_write_b128 v7, v[52:55] offset:96
    v_mul_f32 v128, v142, v35
    v_mul_f32 v129, v143, v35
    v_fmac_f32 v128, v143, v37
    v_fmac_f32 v129, v142, v36
    v_mul_f32 v130, v128, v35
    v_mul_f32 v131, v129, v35
    v_fmac_f32 v130, v129, v37
    v_fmac_f32 v131, v128, v36
    v_mul_f32 v132, v130, v35
    v_mul_f32 v133, v131, v35
    v_fmac_f32 v132, v131, v37
    v_fmac_f32 v133, v130, v36
    v_mul_f32 v134, v132, v35
    v_mul_f32 v135, v133, v35
    v_fmac_f32 v134, v133, v37
    v_fmac_f32 v135, v132, v36
    v_mul_f32 v136, v134, v35
    v_mul_f32 v137, v135, v35
    v_fmac_f32 v136, v135, v37
    v_fmac_f32 v137, v134, v36
    v_mul_f32 v138, v136, v35
    v_mul_f32 v139, v137, v35
    v_fmac_f32 v138, v137, v37
    v_fmac_f32 v139, v136, v36
    v_mul_f32 v140, v138, v35
    v_mul_f32 v141, v139, v35
    v_fmac_f32 v140, v139, v37
    v_fmac_f32 v141, v138, v36
    v_mul_f32 v142, v140, v35
    v_mul_f32 v143, v141, v35
    v_fmac_f32 v142, v141, v37
    v_fmac_f32 v143, v140, v36
    v_cvt_pk_bf16_f32 v48, v128, v130
    v_cvt_pk_bf16_f32 v49, v132, v134
    v_cvt_pk_bf16_f32 v50, v136, v138
    v_cvt_pk_bf16_f32 v51, v140, v142
    ds_write_b128 v7, v[48:51] offset:48
    v_cvt_pk_bf16_f32 v52, -v129, -v131
    v_cvt_pk_bf16_f32 v53, -v133, -v135
    v_cvt_pk_bf16_f32 v54, -v137, -v139
    v_cvt_pk_bf16_f32 v55, -v141, -v143
    ds_write_b128 v7, v[52:55] offset:112
    v_mul_f32 v41, v32, v32
    v_mul_f32 v42, v33, v32
    v_fmac_f32 v41, v33, v34
    v_fmac_f32 v42, v32, v33
    v_sub_f32 v43, 0, v42
    v_mul_f32 v44, v41, v41
    v_mul_f32 v45, v42, v41
    v_fmac_f32 v44, v42, v43
    v_fmac_f32 v45, v41, v42
    v_sub_f32_e64 v46, 0, v45
    s_waitcnt lgkmcnt(0)
    ds_read_b64_tr_b16 v[64:65], v1 offset:0
    ds_read_b64_tr_b16 v[66:67], v1 offset:64
    ds_read_b64_tr_b16 v[68:69], v1 offset:1152
    ds_read_b64_tr_b16 v[70:71], v1 offset:1216
    ds_read_b64_tr_b16 v[72:73], v1 offset:2304
    ds_read_b64_tr_b16 v[74:75], v1 offset:2368
    ds_read_b64_tr_b16 v[76:77], v1 offset:3456
    ds_read_b64_tr_b16 v[78:79], v1 offset:3520
    ds_read_b64_tr_b16 v[80:81], v1 offset:4608
    ds_read_b64_tr_b16 v[82:83], v1 offset:4672
    ds_read_b64_tr_b16 v[84:85], v1 offset:5760
    ds_read_b64_tr_b16 v[86:87], v1 offset:5824
    ds_read_b64_tr_b16 v[88:89], v1 offset:6912
    ds_read_b64_tr_b16 v[90:91], v1 offset:6976
    ds_read_b64_tr_b16 v[92:93], v1 offset:8064
    ds_read_b64_tr_b16 v[94:95], v1 offset:8128
    v_mul_f32 v130, v56, v32
    v_mul_f32 v131, v57, v32
    v_fmac_f32 v130, v57, v34
    v_fmac_f32 v131, v56, v33
    v_mul_f32 v132, v130, v32
    v_mul_f32 v133, v131, v32
    v_fmac_f32 v132, v131, v34
    v_fmac_f32 v133, v130, v33
    v_mul_f32 v134, v132, v32
    v_mul_f32 v135, v133, v32
    v_fmac_f32 v134, v133, v34
    v_fmac_f32 v135, v132, v33
    v_mul_f32 v136, v134, v32
    v_mul_f32 v137, v135, v32
    v_fmac_f32 v136, v135, v34
    v_fmac_f32 v137, v134, v33
    v_mul_f32 v138, v136, v32
    v_mul_f32 v139, v137, v32
    v_fmac_f32 v138, v137, v34
    v_fmac_f32 v139, v136, v33
    v_mul_f32 v140, v138, v32
    v_mul_f32 v141, v139, v32
    v_fmac_f32 v140, v139, v34
    v_fmac_f32 v141, v138, v33
    v_mul_f32 v142, v140, v32
    v_mul_f32 v143, v141, v32
    v_fmac_f32 v142, v141, v34
    v_fmac_f32 v143, v140, v33
    s_waitcnt lgkmcnt(0)
    v_cvt_pk_bf16_f32 v48, v56, v130
    v_cvt_pk_bf16_f32 v49, v132, v134
    v_cvt_pk_bf16_f32 v50, v136, v138
    s_nop 0
    v_cvt_pk_bf16_f32 v51, v140, v142
    ds_write_b128 v7, v[48:51] offset:0
    v_cvt_pk_bf16_f32 v52, v57, v131
    v_cvt_pk_bf16_f32 v53, v133, v135
    v_cvt_pk_bf16_f32 v54, v137, v139
    v_cvt_pk_bf16_f32 v55, v141, v143
    ds_write_b128 v7, v[52:55] offset:64
    v_mul_f32 v58, v56, v38
    v_mul_f32 v59, v57, v38
    v_fmac_f32 v58, v57, v40
    v_fmac_f32 v59, v56, v39
    v_mul_f32 v130, v58, v41
    v_mul_f32 v131, v59, v41
    v_fmac_f32 v130, v59, v43
    v_fmac_f32 v131, v58, v42
    v_mul_f32 v132, v130, v41
    v_mul_f32 v133, v131, v41
    v_fmac_f32 v132, v131, v43
    v_fmac_f32 v133, v130, v42
    v_mul_f32 v134, v132, v41
    v_mul_f32 v135, v133, v41
    v_fmac_f32 v134, v133, v43
    v_fmac_f32 v135, v132, v42
    v_mul_f32 v136, v134, v41
    v_mul_f32 v137, v135, v41
    v_fmac_f32 v136, v135, v43
    v_fmac_f32 v137, v134, v42
    v_cvt_pk_bf16_f32 v48, v58, v130
    v_cvt_pk_bf16_f32 v49, v132, v132
    v_cvt_pk_bf16_f32 v50, v132, v134
    v_cvt_pk_bf16_f32 v51, v136, v136
    ds_write_b128 v7, v[48:51] offset:16
    v_cvt_pk_bf16_f32 v52, v59, v131
    v_cvt_pk_bf16_f32 v53, v133, v133
    v_cvt_pk_bf16_f32 v54, v133, v135
    v_cvt_pk_bf16_f32 v55, v137, v137
    ds_write_b128 v7, v[52:55] offset:80
    v_mul_f32 v56, v58, v38
    v_mul_f32 v57, v59, v38
    v_fmac_f32 v56, v59, v40
    v_fmac_f32 v57, v58, v39
    v_mul_f32 v128, v56, v44
    v_mul_f32 v129, v57, v44
    v_fmac_f32 v128, v57, v46
    v_fmac_f32 v129, v56, v45
    v_mul_f32 v130, v128, v44
    v_mul_f32 v131, v129, v44
    v_fmac_f32 v130, v129, v46
    v_fmac_f32 v131, v128, v45
    v_mul_f32 v58, v56, v38
    v_mul_f32 v59, v57, v38
    v_fmac_f32 v58, v57, v40
    v_fmac_f32 v59, v56, v39
    v_mul_f32 v132, v58, v44
    v_mul_f32 v133, v59, v44
    v_fmac_f32 v132, v59, v46
    v_fmac_f32 v133, v58, v45
    v_mul_f32 v134, v132, v44
    v_mul_f32 v135, v133, v44
    v_fmac_f32 v134, v133, v46
    v_fmac_f32 v135, v132, v45
    v_cvt_pk_bf16_f32 v48, v56, v128
    v_cvt_pk_bf16_f32 v49, v58, v132
    v_cvt_pk_bf16_f32 v50, v128, v130
    v_cvt_pk_bf16_f32 v51, v132, v134
    ds_write_b128 v7, v[48:51] offset:32
    v_cvt_pk_bf16_f32 v52, v57, v129
    v_cvt_pk_bf16_f32 v53, v59, v133
    v_cvt_pk_bf16_f32 v54, v129, v131
    v_cvt_pk_bf16_f32 v55, v133, v135
    ds_write_b128 v7, v[52:55] offset:96
    v_mul_f32 v128, v58, v38
    v_mul_f32 v129, v59, v38
    v_fmac_f32 v128, v59, v40
    v_fmac_f32 v129, v58, v39
    v_mul_f32 v130, v128, v38
    v_mul_f32 v131, v129, v38
    v_fmac_f32 v130, v129, v40
    v_fmac_f32 v131, v128, v39
    v_mul_f32 v132, v130, v38
    v_mul_f32 v133, v131, v38
    v_fmac_f32 v132, v131, v40
    v_fmac_f32 v133, v130, v39
    v_mul_f32 v134, v132, v38
    v_mul_f32 v135, v133, v38
    v_fmac_f32 v134, v133, v40
    v_fmac_f32 v135, v132, v39
    v_mul_f32 v136, v128, v35
    v_mul_f32 v137, v129, v35
    v_fmac_f32 v136, v129, v37
    v_fmac_f32 v137, v128, v36
    v_mul_f32 v138, v130, v35
    v_mul_f32 v139, v131, v35
    v_fmac_f32 v138, v131, v37
    v_fmac_f32 v139, v130, v36
    v_mul_f32 v140, v132, v35
    v_mul_f32 v141, v133, v35
    v_fmac_f32 v140, v133, v37
    v_fmac_f32 v141, v132, v36
    v_mul_f32 v142, v134, v35
    v_mul_f32 v143, v135, v35
    v_fmac_f32 v142, v135, v37
    v_fmac_f32 v143, v134, v36
    v_cvt_pk_bf16_f32 v48, v128, v130
    v_cvt_pk_bf16_f32 v49, v132, v134
    v_cvt_pk_bf16_f32 v50, v136, v138
    v_cvt_pk_bf16_f32 v51, v140, v142
    ds_write_b128 v7, v[48:51] offset:48
    v_cvt_pk_bf16_f32 v52, v129, v131
    v_cvt_pk_bf16_f32 v53, v133, v135
    v_cvt_pk_bf16_f32 v54, v137, v139
    v_cvt_pk_bf16_f32 v55, v141, v143
    ds_write_b128 v7, v[52:55] offset:112
    s_waitcnt lgkmcnt(0)
    s_nop 0
    ds_read_b64_tr_b16 v[96:97], v1 offset:0
    ds_read_b64_tr_b16 v[98:99], v1 offset:64
    ds_read_b64_tr_b16 v[100:101], v1 offset:1152
    ds_read_b64_tr_b16 v[102:103], v1 offset:1216
    ds_read_b64_tr_b16 v[104:105], v1 offset:2304
    ds_read_b64_tr_b16 v[106:107], v1 offset:2368
    ds_read_b64_tr_b16 v[108:109], v1 offset:3456
    ds_read_b64_tr_b16 v[110:111], v1 offset:3520
    ds_read_b64_tr_b16 v[112:113], v1 offset:4608
    ds_read_b64_tr_b16 v[114:115], v1 offset:4672
    ds_read_b64_tr_b16 v[116:117], v1 offset:5760
    ds_read_b64_tr_b16 v[118:119], v1 offset:5824
    ds_read_b64_tr_b16 v[120:121], v1 offset:6912
    ds_read_b64_tr_b16 v[122:123], v1 offset:6976
    ds_read_b64_tr_b16 v[124:125], v1 offset:8064
    ds_read_b64_tr_b16 v[126:127], v1 offset:8128
    s_waitcnt lgkmcnt(14)
    v_mfma_f32_32x32x16_bf16 v[232:247], v[96:99], v[64:67], v[232:247]
    s_waitcnt lgkmcnt(12)
    v_mfma_f32_32x32x16_bf16 v[232:247], v[100:103], v[68:71], v[232:247]
    s_waitcnt lgkmcnt(10)
    v_mfma_f32_32x32x16_bf16 v[232:247], v[104:107], v[72:75], v[232:247]
    s_waitcnt lgkmcnt(8)
    v_mfma_f32_32x32x16_bf16 v[232:247], v[108:111], v[76:79], v[232:247]
    s_waitcnt lgkmcnt(6)
    v_mfma_f32_32x32x16_bf16 v[232:247], v[112:115], v[80:83], v[232:247]
    s_waitcnt lgkmcnt(4)
    v_mfma_f32_32x32x16_bf16 v[232:247], v[116:119], v[84:87], v[232:247]
    s_waitcnt lgkmcnt(2)
    v_mfma_f32_32x32x16_bf16 v[232:247], v[120:123], v[88:91], v[232:247]
    s_waitcnt lgkmcnt(0)
    v_mfma_f32_32x32x16_bf16 v[232:247], v[124:127], v[92:95], v[232:247]
    s_mul_i32 s38, s21, 4352
    s_xor_b32 s35, s3, 1
    s_lshl_b32 s35, s35, 2
    v_add_u32 v21, s35, v22
    s_cmp_eq_u32 s22, 0
    s_cbranch_scc1 L_B_fin
    v_add_u32 v1, s39, v2
    s_nop 4
    ds_write_b128 v1, v[232:235] offset:0
    ds_write_b128 v1, v[236:239] offset:1024
    ds_write_b128 v1, v[240:243] offset:2048
    ds_write_b128 v1, v[244:247] offset:3072
    s_waitcnt lgkmcnt(0)
    v_mov_b32 v23, 100
    ds_write_b32 v29, v23
    s_branch L_B_join
L_B_fin:
    s_add_u32 s35, s39, 9216
    v_add_u32_e64 v1, s35, v2
    s_mov_b32 s62, 1048576
L_wbp:
    ds_read_b32 v32, v21 offset:0
    s_waitcnt lgkmcnt(0)
    v_cmp_gt_u32 vcc, 100, v32
    s_cbranch_vccz L_wbp_ok
    s_sleep 1
    s_sub_u32 s62, s62, 1
    s_cbranch_scc0 L_wbp
L_wbp_ok:
    ds_read_b128 v[80:83], v1 offset:0
    ds_read_b128 v[84:87], v1 offset:1024
    ds_read_b128 v[88:91], v1 offset:2048
    ds_read_b128 v[92:95], v1 offset:3072
    v_and_b32 v5, 31, v0
    v_lshlrev_b32 v5, 4, v5
    v_lshrrev_b32 v7, 5, v0
    v_xor_b32 v6, 1, v7
    v_lshl_add_u32 v5, v6, 3, v5
    s_add_u32 s35, s38, 140032
    v_add_u32 v5, s35, v5
    v_lshlrev_b32 v6, 2, v0
    s_add_u32 s35, s38, 139776
    v_add_u32 v6, s35, v6
    s_waitcnt lgkmcnt(0)
    v_mov_b32 v23, 100
    ds_write_b32 v29, v23
    v_add_f32 v64, v232, v80
    v_add_f32 v65, v233, v81
    v_add_f32 v66, v234, v82
    v_add_f32 v67, v235, v83
    v_add_f32 v68, v236, v84
    v_add_f32 v69, v237, v85
    v_add_f32 v70, v238, v86
    v_add_f32 v71, v239, v87
    v_add_f32 v72, v240, v88
    v_add_f32 v73, v241, v89
    v_add_f32 v74, v242, v90
    v_add_f32 v75, v243, v91
    v_add_f32 v76, v244, v92
    v_add_f32 v77, v245, v93
    v_add_f32 v78, v246, v94
    v_add_f32 v79, v247, v95
    v_cmp_eq_u32 vcc, 1, v7
    s_nop 1
    v_cndmask_b32 v80, v72, v73, vcc
    v_cndmask_b32 v81, v74, v75, vcc
    v_and_b32 v7, 1, v0
    v_cmp_eq_u32 vcc, 1, v7
    v_mov_b32 v84, v76
    v_mov_b32 v88, v76
    v_mov_b32 v85, v77
    v_mov_b32 v89, v77
    v_mov_b32 v86, v78
    v_mov_b32 v90, v78
    v_mov_b32 v87, v79
    v_mov_b32 v91, v79
    v_permlane32_swap_b32 v84, v88
    v_permlane32_swap_b32 v85, v89
    v_permlane32_swap_b32 v86, v90
    v_permlane32_swap_b32 v87, v91
    v_cndmask_b32 v84, v84, v76, vcc
    v_cndmask_b32 v85, v85, v77, vcc
    v_cndmask_b32 v86, v86, v78, vcc
    v_cndmask_b32 v87, v87, v79, vcc
    v_cvt_pk_bf16_f32 v96, v67, v66
    v_cvt_pk_bf16_f32 v97, v65, v64
    v_cvt_pk_bf16_f32 v98, v70, v69
    v_cvt_pk_bf16_f32 v99, v68, v68
    v_cvt_pk_bf16_f32 v100, v73, v80
    v_cvt_pk_bf16_f32 v101, v72, v72
    v_cvt_pk_bf16_f32 v102, v75, v81
    v_cvt_pk_bf16_f32 v103, v74, v74
    v_cvt_pk_bf16_f32 v104, v76, v76
    v_cvt_pk_bf16_f32 v105, v76, v84
    v_cvt_pk_bf16_f32 v106, v77, v77
    v_cvt_pk_bf16_f32 v107, v77, v85
    v_cvt_pk_bf16_f32 v108, v78, v78
    v_cvt_pk_bf16_f32 v109, v78, v86
    v_cvt_pk_bf16_f32 v110, v79, v79
    v_cvt_pk_bf16_f32 v111, v79, v87
    s_mov_b32 s62, 1048576
L_wbb0:
    ds_read_b128 v[32:35], v22 offset:16
    s_waitcnt lgkmcnt(0)
    v_min3_u32 v32, v32, v33, v34
    v_min_u32 v32, v32, v35
    v_cmp_gt_u32 vcc, 100, v32
    s_cbranch_vccz L_wbb0_ok
    s_sleep 1
    s_sub_u32 s62, s62, 1
    s_cbranch_scc0 L_wbb0
L_wbb0_ok:
    v_mov_b32_e64 v3, 0
    ds_write_b32 v6, v3
    ds_write_b64 v5, v[96:97] offset:0
    ds_write_b64 v5, v[98:99] offset:512
    ds_write_b64 v5, v[100:101] offset:1024
    ds_write_b64 v5, v[102:103] offset:1536
    ds_write_b64 v5, v[104:105] offset:2048
    ds_write_b64 v5, v[106:107] offset:2560
    ds_write_b64 v5, v[108:109] offset:3072
    ds_write_b64 v5, v[110:111] offset:3584
    s_waitcnt lgkmcnt(0)
L_B_join:
    v_mov_b32 v23, 101
    ds_write_b32 v29, v23
    v_sub_u32 v5, v8, v9
    v_lshlrev_b32_e64 v5, 4, v5
    s_add_u32 s35, s38, 143680
    v_add_u32 v5, s35, v5
    v_cmp_ne_u32 vcc, 8, v8
    s_nop 1
    v_cndmask_b32 v15, 0, -1, vcc
    v_cmp_gt_u32 vcc, 8, v8
    v_alignbit_b32 v32, v145, v144, 16
    v_mov_b32 v36, v145
    v_alignbit_b32 v40, v146, v145, 16
    v_alignbit_b32 v33, v146, v145, 16
    v_mov_b32 v37, v146
    v_alignbit_b32 v41, v147, v146, 16
    v_alignbit_b32 v34, v147, v146, 16
    v_mov_b32_e64 v38, v147
    v_alignbit_b32 v42, v148, v147, 16
    v_alignbit_b32 v35, v148, v147, 16
    v_mov_b32 v39, v148
    v_alignbit_b32 v43, v149, v148, 16
    v_alignbit_b32 v44, v151, v150, 16
    v_mov_b32 v48, v151
    v_alignbit_b32 v52, v152, v151, 16
    v_alignbit_b32 v45, v152, v151, 16
    v_mov_b32_e64 v49, v152
    v_alignbit_b32 v53, v153, v152, 16
    v_alignbit_b32 v46, v153, v152, 16
    v_mov_b32 v50, v153
    v_alignbit_b32 v54, v154, v153, 16
    v_alignbit_b32 v47, v154, v153, 16
    v_mov_b32 v51, v154
    v_alignbit_b32 v55, v155, v154, 16
    v_alignbit_b32 v56, v157, v156, 16
    v_mov_b32_e64 v60, v157
    v_alignbit_b32 v64, v158, v157, 16
    v_alignbit_b32 v57, v158, v157, 16
    v_mov_b32 v61, v158
    v_alignbit_b32 v65, v159, v158, 16
    v_alignbit_b32 v58, v159, v158, 16
    v_mov_b32 v62, v159
    v_alignbit_b32 v66, v160, v159, 16
    v_alignbit_b32 v59, v160, v159, 16
    v_mov_b32_e64 v63, v160
    v_alignbit_b32 v67, v161, v160, 16
    v_alignbit_b32 v68, v163, v162, 16
    v_mov_b32 v72, v163
    v_alignbit_b32 v76, v164, v163, 16
    v_alignbit_b32 v69, v164, v163, 16
    v_mov_b32 v73, v164
    v_alignbit_b32 v77, v165, v164, 16
    v_alignbit_b32 v70, v165, v164, 16
    v_mov_b32_e64 v74, v165
    v_alignbit_b32 v78, v166, v165, 16
    v_alignbit_b32 v71, v166, v165, 16
    v_mov_b32_e64 v75, v166
    v_alignbit_b32 v79, v167, v166, 16
    v_cndmask_b32_dpp v80, v36, v32, vcc row_shr:8 row_mask:0xf bank_mask:0xf bound_ctrl:1
    v_cndmask_b32_dpp v81, v37, v33, vcc row_shr:8 row_mask:0xf bank_mask:0xf bound_ctrl:1
    v_cndmask_b32_dpp v82, v38, v34, vcc row_shr:8 row_mask:0xf bank_mask:0xf bound_ctrl:1
    v_cndmask_b32_dpp v83, v39, v35, vcc row_shr:8 row_mask:0xf bank_mask:0xf bound_ctrl:1
    v_cndmask_b32_dpp v84, v146, v40, vcc row_shr:8 row_mask:0xf bank_mask:0xf bound_ctrl:1
    v_cndmask_b32_dpp v85, v147, v41, vcc row_shr:8 row_mask:0xf bank_mask:0xf bound_ctrl:1
    v_cndmask_b32_dpp v86, v148, v42, vcc row_shr:8 row_mask:0xf bank_mask:0xf bound_ctrl:1
    v_cndmask_b32_dpp v87, v149, v43, vcc row_shr:8 row_mask:0xf bank_mask:0xf bound_ctrl:1
    v_cndmask_b32_dpp v88, v48, v44, vcc row_shr:8 row_mask:0xf bank_mask:0xf bound_ctrl:1
    v_cndmask_b32_dpp v89, v49, v45, vcc row_shr:8 row_mask:0xf bank_mask:0xf bound_ctrl:1
    v_cndmask_b32_dpp v90, v50, v46, vcc row_shr:8 row_mask:0xf bank_mask:0xf bound_ctrl:1
    v_cndmask_b32_dpp v91, v51, v47, vcc row_shr:8 row_mask:0xf bank_mask:0xf bound_ctrl:1
    v_cndmask_b32_dpp v92, v152, v52, vcc row_shr:8 row_mask:0xf bank_mask:0xf bound_ctrl:1
    v_cndmask_b32_dpp v93, v153, v53, vcc row_shr:8 row_mask:0xf bank_mask:0xf bound_ctrl:1
    v_cndmask_b32_dpp v94, v154, v54, vcc row_shr:8 row_mask:0xf bank_mask:0xf bound_ctrl:1
    v_cndmask_b32_dpp v95, v155, v55, vcc row_shr:8 row_mask:0xf bank_mask:0xf bound_ctrl:1
    v_cndmask_b32_dpp v96, v60, v56, vcc row_shr:8 row_mask:0xf bank_mask:0xf bound_ctrl:1
    v_cndmask_b32_dpp v97, v61, v57, vcc row_shr:8 row_mask:0xf bank_mask:0xf bound_ctrl:1
    v_cndmask_b32_dpp v98, v62, v58, vcc row_shr:8 row_mask:0xf bank_mask:0xf bound_ctrl:1
    v_cndmask_b32_dpp v99, v63, v59, vcc row_shr:8 row_mask:0xf bank_mask:0xf bound_ctrl:1
    v_cndmask_b32_dpp v100, v158, v64, vcc row_shr:8 row_mask:0xf bank_mask:0xf bound_ctrl:1
    v_cndmask_b32_dpp v101, v159, v65, vcc row_shr:8 row_mask:0xf bank_mask:0xf bound_ctrl:1
    v_cndmask_b32_dpp v102, v160, v66, vcc row_shr:8 row_mask:0xf bank_mask:0xf bound_ctrl:1
    v_cndmask_b32_dpp v103, v161, v67, vcc row_shr:8 row_mask:0xf bank_mask:0xf bound_ctrl:1
    v_cndmask_b32_dpp v104, v72, v68, vcc row_shr:8 row_mask:0xf bank_mask:0xf bound_ctrl:1
    v_cndmask_b32_dpp v105, v73, v69, vcc row_shr:8 row_mask:0xf bank_mask:0xf bound_ctrl:1
    v_cndmask_b32_dpp v106, v74, v70, vcc row_shr:8 row_mask:0xf bank_mask:0xf bound_ctrl:1
    v_cndmask_b32_dpp v107, v75, v71, vcc row_shr:8 row_mask:0xf bank_mask:0xf bound_ctrl:1
    v_cndmask_b32_dpp v108, v164, v76, vcc row_shr:8 row_mask:0xf bank_mask:0xf bound_ctrl:1
    v_cndmask_b32_dpp v109, v165, v77, vcc row_shr:8 row_mask:0xf bank_mask:0xf bound_ctrl:1
    v_cndmask_b32_dpp v110, v166, v78, vcc row_shr:8 row_mask:0xf bank_mask:0xf bound_ctrl:1
    v_cndmask_b32_dpp v111, v167, v79, vcc row_shr:8 row_mask:0xf bank_mask:0xf bound_ctrl:1
    v_mov_b32 v192, 0
    v_mov_b32 v193, 0
    v_mov_b32 v194, 0
    v_mov_b32 v195, 0
    v_mov_b32 v196, 0
    v_mov_b32 v197, 0
    v_mov_b32 v198, 0
    v_mov_b32 v199, 0
    s_mov_b32 s62, 1048576
L_wbq:
    ds_read_b32 v216, v21 offset:0
    s_waitcnt lgkmcnt(0)
    v_cmp_gt_u32 vcc, 101, v216
    s_cbranch_vccz L_wbq_ok
    s_sleep 1
    s_sub_u32 s62, s62, 1
    s_cbranch_scc0 L_wbq
L_wbq_ok:
    ds_read_b128 v[112:115], v5 offset:192
    ds_read_b128 v[116:119], v5 offset:128
    ds_read_b128 v[120:123], v5 offset:64
    ds_read_b128 v[124:127], v5 offset:0
    v_add_u32 v5, -256, v5
    s_mov_b32 s7, 0
L_B_pk:
    ds_read_b128 v[128:131], v5 offset:192
    ds_read_b128 v[132:135], v5 offset:128
    ds_read_b128 v[136:139], v5 offset:64
    ds_read_b128 v[140:143], v5 offset:0
    v_add_u32 v5, -256, v5
    v_and_b32_dpp v192, v192, v15 row_shr:1 row_mask:0xf bank_mask:0xf bound_ctrl:1
    v_and_b32_dpp v193, v193, v15 row_shr:1 row_mask:0xf bank_mask:0xf bound_ctrl:1
    v_and_b32_dpp v194, v194, v15 row_shr:1 row_mask:0xf bank_mask:0xf bound_ctrl:1
    v_and_b32_dpp v195, v195, v15 row_shr:1 row_mask:0xf bank_mask:0xf bound_ctrl:1
    s_waitcnt lgkmcnt(4)
    s_nop 0
    v_mfma_f32_16x16x32_bf16 v[192:195], v[112:115], v[80:83], v[192:195]
    v_and_b32_dpp v196, v196, v15 row_shr:1 row_mask:0xf bank_mask:0xf bound_ctrl:1
    v_mfma_f32_16x16x32_bf16 v[192:195], v[116:119], v[88:91], v[192:195]
    v_and_b32_dpp v197, v197, v15 row_shr:1 row_mask:0xf bank_mask:0xf bound_ctrl:1
    v_mfma_f32_16x16x32_bf16 v[192:195], v[120:123], v[96:99], v[192:195]
    v_and_b32_dpp v198, v198, v15 row_shr:1 row_mask:0xf bank_mask:0xf bound_ctrl:1
    v_mfma_f32_16x16x32_bf16 v[192:195], v[124:127], v[104:107], v[192:195]
    v_and_b32_dpp v199, v199, v15 row_shr:1 row_mask:0xf bank_mask:0xf bound_ctrl:1
    s_nop 1
    v_mfma_f32_16x16x32_bf16 v[196:199], v[112:115], v[84:87], v[196:199]
    v_mfma_f32_16x16x32_bf16 v[196:199], v[116:119], v[92:95], v[196:199]
    v_mfma_f32_16x16x32_bf16 v[196:199], v[120:123], v[100:103], v[196:199]
    s_nop 0
    v_mfma_f32_16x16x32_bf16 v[196:199], v[124:127], v[108:111], v[196:199]
    ds_read_b128 v[112:115], v5 offset:192
    ds_read_b128 v[116:119], v5 offset:128
    ds_read_b128 v[120:123], v5 offset:64
    ds_read_b128 v[124:127], v5 offset:0
    v_add_u32 v5, -256, v5
    v_and_b32_dpp v192, v192, v15 row_shr:1 row_mask:0xf bank_mask:0xf bound_ctrl:1
    v_and_b32_dpp v193, v193, v15 row_shr:1 row_mask:0xf bank_mask:0xf bound_ctrl:1
    v_and_b32_dpp v194, v194, v15 row_shr:1 row_mask:0xf bank_mask:0xf bound_ctrl:1
    v_and_b32_dpp v195, v195, v15 row_shr:1 row_mask:0xf bank_mask:0xf bound_ctrl:1
    s_waitcnt lgkmcnt(4)
    s_nop 0
    v_mfma_f32_16x16x32_bf16 v[192:195], v[128:131], v[80:83], v[192:195]
    v_and_b32_dpp v196, v196, v15 row_shr:1 row_mask:0xf bank_mask:0xf bound_ctrl:1
    v_mfma_f32_16x16x32_bf16 v[192:195], v[132:135], v[88:91], v[192:195]
    v_and_b32_dpp v197, v197, v15 row_shr:1 row_mask:0xf bank_mask:0xf bound_ctrl:1
    v_mfma_f32_16x16x32_bf16 v[192:195], v[136:139], v[96:99], v[192:195]
    v_and_b32_dpp v198, v198, v15 row_shr:1 row_mask:0xf bank_mask:0xf bound_ctrl:1
    v_mfma_f32_16x16x32_bf16 v[192:195], v[140:143], v[104:107], v[192:195]
    v_and_b32_dpp v199, v199, v15 row_shr:1 row_mask:0xf bank_mask:0xf bound_ctrl:1
    s_nop 1
    v_mfma_f32_16x16x32_bf16 v[196:199], v[128:131], v[84:87], v[196:199]
    v_mfma_f32_16x16x32_bf16 v[196:199], v[132:135], v[92:95], v[196:199]
    v_mfma_f32_16x16x32_bf16 v[196:199], v[136:139], v[100:103], v[196:199]
    v_mfma_f32_16x16x32_bf16 v[196:199], v[140:143], v[108:111], v[196:199]
    s_add_u32 s7, s7, 1
    s_cmp_lt_u32 s7, 4
    s_cbranch_scc1 L_B_pk
    v_mov_b32_dpp v176, v192 row_shr:1 row_mask:0xf bank_mask:0xf bound_ctrl:1
    v_mov_b32_dpp v177, v193 row_shr:1 row_mask:0xf bank_mask:0xf bound_ctrl:1
    v_mov_b32_dpp v178, v194 row_shr:1 row_mask:0xf bank_mask:0xf bound_ctrl:1
    v_mov_b32_dpp v179, v195 row_shr:1 row_mask:0xf bank_mask:0xf bound_ctrl:1
    v_mov_b32_dpp v180, v192 row_shl:8 row_mask:0xf bank_mask:0xf bound_ctrl:1
    v_mov_b32_dpp v181, v193 row_shl:8 row_mask:0xf bank_mask:0xf bound_ctrl:1
    v_mov_b32_dpp v182, v194 row_shl:8 row_mask:0xf bank_mask:0xf bound_ctrl:1
    v_mov_b32_dpp v183, v195 row_shl:8 row_mask:0xf bank_mask:0xf bound_ctrl:1
    v_mov_b32 v184, v196
    v_mov_b32 v185, v197
    v_mov_b32 v186, v198
    v_mov_b32 v187, v199
    v_mov_b32_dpp v188, v196 row_shl:8 row_mask:0xf bank_mask:0xf bound_ctrl:1
    v_mov_b32_dpp v189, v197 row_shl:8 row_mask:0xf bank_mask:0xf bound_ctrl:1
    v_mov_b32_dpp v190, v198 row_shl:8 row_mask:0xf bank_mask:0xf bound_ctrl:1
    v_mov_b32_dpp v191, v199 row_shl:8 row_mask:0xf bank_mask:0xf bound_ctrl:1
    s_mov_b32 s7, 0
L_B_fl:
    ds_read_b128 v[128:131], v5 offset:192
    ds_read_b128 v[132:135], v5 offset:128
    ds_read_b128 v[136:139], v5 offset:64
    ds_read_b128 v[140:143], v5 offset:0
    v_add_u32 v5, -256, v5
    s_waitcnt lgkmcnt(4)
    v_mfma_f32_16x16x32_bf16 v[176:179], v[112:115], v[32:35], v[176:179]
    v_mov_b32_dpp v180, v180 row_shr:1 row_mask:0xf bank_mask:0xf bound_ctrl:1
    v_mfma_f32_16x16x32_bf16 v[176:179], v[116:119], v[44:47], v[176:179]
    v_mov_b32_dpp v181, v181 row_shr:1 row_mask:0xf bank_mask:0xf bound_ctrl:1
    v_mfma_f32_16x16x32_bf16 v[176:179], v[120:123], v[56:59], v[176:179]
    v_mov_b32_dpp v182, v182 row_shr:1 row_mask:0xf bank_mask:0xf bound_ctrl:1
    v_mfma_f32_16x16x32_bf16 v[176:179], v[124:127], v[68:71], v[176:179]
    v_mov_b32_dpp v183, v183 row_shr:1 row_mask:0xf bank_mask:0xf bound_ctrl:1
    s_nop 1
    v_mfma_f32_16x16x32_bf16 v[180:183], v[112:115], v[36:39], v[180:183]
    v_mov_b32_dpp v184, v184 row_shr:1 row_mask:0xf bank_mask:0xf bound_ctrl:1
    v_mfma_f32_16x16x32_bf16 v[180:183], v[116:119], v[48:51], v[180:183]
    v_mov_b32_dpp v185, v185 row_shr:1 row_mask:0xf bank_mask:0xf bound_ctrl:1
    v_mfma_f32_16x16x32_bf16 v[180:183], v[120:123], v[60:63], v[180:183]
    v_mov_b32_dpp v186, v186 row_shr:1 row_mask:0xf bank_mask:0xf bound_ctrl:1
    v_mfma_f32_16x16x32_bf16 v[180:183], v[124:127], v[72:75], v[180:183]
    v_mov_b32_dpp v187, v187 row_shr:1 row_mask:0xf bank_mask:0xf bound_ctrl:1
    s_nop 1
    v_mfma_f32_16x16x32_bf16 v[184:187], v[112:115], v[40:43], v[184:187]
    v_mov_b32_dpp v188, v188 row_shr:1 row_mask:0xf bank_mask:0xf bound_ctrl:1
    v_mfma_f32_16x16x32_bf16 v[184:187], v[116:119], v[52:55], v[184:187]
    v_mov_b32_dpp v189, v189 row_shr:1 row_mask:0xf bank_mask:0xf bound_ctrl:1
    v_mfma_f32_16x16x32_bf16 v[184:187], v[120:123], v[64:67], v[184:187]
    v_mov_b32_dpp v190, v190 row_shr:1 row_mask:0xf bank_mask:0xf bound_ctrl:1
    v_mfma_f32_16x16x32_bf16 v[184:187], v[124:127], v[76:79], v[184:187]
    v_mov_b32_dpp v191, v191 row_shr:1 row_mask:0xf bank_mask:0xf bound_ctrl:1
    s_nop 1
    v_mfma_f32_16x16x32_bf16 v[188:191], v[112:115], v[146:149], v[188:191]
    s_nop 0
    v_mov_b32_dpp v176, v176 row_shr:1 row_mask:0xf bank_mask:0xf bound_ctrl:1
    v_mfma_f32_16x16x32_bf16 v[188:191], v[116:119], v[152:155], v[188:191]
    v_mov_b32_dpp v177, v177 row_shr:1 row_mask:0xf bank_mask:0xf bound_ctrl:1
    v_mfma_f32_16x16x32_bf16 v[188:191], v[120:123], v[158:161], v[188:191]
    v_mov_b32_dpp v178, v178 row_shr:1 row_mask:0xf bank_mask:0xf bound_ctrl:1
    v_mfma_f32_16x16x32_bf16 v[188:191], v[124:127], v[164:167], v[188:191]
    v_mov_b32_dpp v179, v179 row_shr:1 row_mask:0xf bank_mask:0xf bound_ctrl:1
    ds_read_b128 v[112:115], v5 offset:192
    ds_read_b128 v[116:119], v5 offset:128
    ds_read_b128 v[120:123], v5 offset:64
    ds_read_b128 v[124:127], v5 offset:0
    v_add_u32 v5, -256, v5
    s_waitcnt lgkmcnt(4)
    v_mfma_f32_16x16x32_bf16 v[176:179], v[128:131], v[32:35], v[176:179]
    v_mov_b32_dpp v180, v180 row_shr:1 row_mask:0xf bank_mask:0xf bound_ctrl:1
    v_mfma_f32_16x16x32_bf16 v[176:179], v[132:135], v[44:47], v[176:179]
    v_mov_b32_dpp v181, v181 row_shr:1 row_mask:0xf bank_mask:0xf bound_ctrl:1
    v_mfma_f32_16x16x32_bf16 v[176:179], v[136:139], v[56:59], v[176:179]
    v_mov_b32_dpp v182, v182 row_shr:1 row_mask:0xf bank_mask:0xf bound_ctrl:1
    v_mfma_f32_16x16x32_bf16 v[176:179], v[140:143], v[68:71], v[176:179]
    v_mov_b32_dpp v183, v183 row_shr:1 row_mask:0xf bank_mask:0xf bound_ctrl:1
    s_nop 1
    v_mfma_f32_16x16x32_bf16 v[180:183], v[128:131], v[36:39], v[180:183]
    v_mov_b32_dpp v184, v184 row_shr:1 row_mask:0xf bank_mask:0xf bound_ctrl:1
    v_mfma_f32_16x16x32_bf16 v[180:183], v[132:135], v[48:51], v[180:183]
    v_mov_b32_dpp v185, v185 row_shr:1 row_mask:0xf bank_mask:0xf bound_ctrl:1
    v_mfma_f32_16x16x32_bf16 v[180:183], v[136:139], v[60:63], v[180:183]
    v_mov_b32_dpp v186, v186 row_shr:1 row_mask:0xf bank_mask:0xf bound_ctrl:1
    v_mfma_f32_16x16x32_bf16 v[180:183], v[140:143], v[72:75], v[180:183]
    v_mov_b32_dpp v187, v187 row_shr:1 row_mask:0xf bank_mask:0xf bound_ctrl:1
    s_nop 1
    v_mfma_f32_16x16x32_bf16 v[184:187], v[128:131], v[40:43], v[184:187]
    v_mov_b32_dpp v188, v188 row_shr:1 row_mask:0xf bank_mask:0xf bound_ctrl:1
    v_mfma_f32_16x16x32_bf16 v[184:187], v[132:135], v[52:55], v[184:187]
    v_mov_b32_dpp v189, v189 row_shr:1 row_mask:0xf bank_mask:0xf bound_ctrl:1
    v_mfma_f32_16x16x32_bf16 v[184:187], v[136:139], v[64:67], v[184:187]
    v_mov_b32_dpp v190, v190 row_shr:1 row_mask:0xf bank_mask:0xf bound_ctrl:1
    v_mfma_f32_16x16x32_bf16 v[184:187], v[140:143], v[76:79], v[184:187]
    v_mov_b32_dpp v191, v191 row_shr:1 row_mask:0xf bank_mask:0xf bound_ctrl:1
    s_add_u32 s7, s7, 1
    s_cmp_eq_u32 s7, 4
    s_cbranch_scc1 L_B_last
    v_mfma_f32_16x16x32_bf16 v[188:191], v[128:131], v[146:149], v[188:191]
    v_mov_b32_dpp v176, v176 row_shr:1 row_mask:0xf bank_mask:0xf bound_ctrl:1
    v_mfma_f32_16x16x32_bf16 v[188:191], v[132:135], v[152:155], v[188:191]
    v_mov_b32_dpp v177, v177 row_shr:1 row_mask:0xf bank_mask:0xf bound_ctrl:1
    v_mfma_f32_16x16x32_bf16 v[188:191], v[136:139], v[158:161], v[188:191]
    v_mov_b32_dpp v178, v178 row_shr:1 row_mask:0xf bank_mask:0xf bound_ctrl:1
    v_mfma_f32_16x16x32_bf16 v[188:191], v[140:143], v[164:167], v[188:191]
    v_mov_b32_dpp v179, v179 row_shr:1 row_mask:0xf bank_mask:0xf bound_ctrl:1
    s_branch L_B_fl
L_B_last:
    s_nop 1
    v_mfma_f32_16x16x32_bf16 v[188:191], v[128:131], v[146:149], v[188:191]
    v_mfma_f32_16x16x32_bf16 v[188:191], v[132:135], v[152:155], v[188:191]
    v_mfma_f32_16x16x32_bf16 v[188:191], v[136:139], v[158:161], v[188:191]
    v_mfma_f32_16x16x32_bf16 v[188:191], v[140:143], v[164:167], v[188:191]
    s_setprio 2
    s_lshl_b32 s35, s22, 3
    s_add_u32 s35, s35, s38
    s_add_u32 s35, s35, 131088
    v_mul_u32_u24 v6, 272, v8
    v_lshl_add_u32 v7, v9, 6, v6
    v_add_u32 v7, s35, v7
    s_lshl_b32 s35, s21, 4
    s_lshr_b32 s30, s30, s35
    s_lshl_b32 s30, s30, 16
    v_mov_b32 v18, s30
    v_mov_b32 v19, s30
    v_lshlrev_b32 v48, 16, v168
    v_and_b32 v49, 0xffff0000, v168
    v_lshlrev_b32 v52, 16, v169
    v_and_b32 v53, 0xffff0000, v169
    v_lshlrev_b32 v56, 16, v170
    v_and_b32 v57, 0xffff0000, v170
    v_lshlrev_b32 v60, 16, v171
    v_and_b32 v61, 0xffff0000, v171
    v_lshlrev_b32 v64, 16, v172
    v_and_b32 v65, 0xffff0000, v172
    v_lshlrev_b32_e64 v68, 16, v173
    v_and_b32 v69, 0xffff0000, v173
    v_lshlrev_b32 v72, 16, v174
    v_and_b32 v73, 0xffff0000, v174
    v_lshlrev_b32 v76, 16, v175
    v_and_b32 v77, 0xffff0000, v175
    v_fmac_f32 v176, v48, v18
    v_fmac_f32 v180, v49, v18
    v_fmac_f32 v184, v52, v18
    v_fmac_f32 v188, v53, v18
    v_fmac_f32 v177, v56, v18
    v_fmac_f32 v181, v57, v18
    v_fmac_f32 v185, v60, v18
    v_fmac_f32 v189, v61, v18
    v_fmac_f32 v178, v64, v18
    v_fmac_f32 v182, v65, v18
    v_fmac_f32 v186, v68, v18
    v_fmac_f32 v190, v69, v18
    v_fmac_f32 v179, v72, v18
    v_fmac_f32 v183, v73, v18
    v_fmac_f32 v187, v76, v18
    v_fmac_f32 v191, v77, v18
    v_cvt_pk_bf16_f32 v168, v176, v180
    v_cvt_pk_bf16_f32 v169, v184, v188
    v_cvt_pk_bf16_f32 v170, v177, v181
    v_cvt_pk_bf16_f32 v171, v185, v189
    v_cvt_pk_bf16_f32 v172, v178, v182
    v_cvt_pk_bf16_f32 v173, v186, v190
    v_cvt_pk_bf16_f32 v174, v179, v183
    v_cvt_pk_bf16_f32 v175, v187, v191
    ds_write_b64 v7, v[168:169] offset:0
    ds_write_b64 v7, v[170:171] offset:16
    ds_write_b64 v7, v[172:173] offset:32
    ds_write_b64 v7, v[174:175] offset:48
    s_lshl_b32 s35, s22, 3
    v_add_u32 v7, s35, v9
    v_mul_u32_u24 v7, 272, v7
    v_lshl_add_u32 v7, v8, 4, v7
    s_add_u32 s35, s38, 131088
    v_add_u32 v7, s35, v7
    s_lshl_b32 s36, s22, 11
    s_add_u32 s36, s36, s23
    s_add_u32 s36, s36, 0x8c0000
    s_waitcnt lgkmcnt(0)
    v_mov_b32 v23, 103
    ds_write_b32 v29, v23
    s_mov_b32 s62, 1048576
L_wbr:
    ds_read_b32 v32, v21 offset:0
    s_waitcnt lgkmcnt(0)
    v_cmp_gt_u32 vcc, 103, v32
    s_cbranch_vccz L_wbr_ok
    s_sleep 1
    s_sub_u32 s62, s62, 1
    s_cbranch_scc0 L_wbr
L_wbr_ok:
    ds_read_b128 v[32:35], v7
    ds_read_b128 v[36:39], v7 offset:1088
    s_waitcnt lgkmcnt(0)
    buffer_store_dwordx4 v[32:35], v2, s[12:15], s36 offen sc1
    buffer_store_dwordx4 v[36:39], v2, s[12:15], s36 offen offset:1024 sc1
    s_lshl_b32 s30, s20, 3
    s_lshl_b32 s35, s22, 2
    s_add_u32 s30, s30, s35
    s_add_u32 s30, s30, 0xae4000
    s_lshl_b32 s39, s29, 9
    s_add_u32 s39, s39, 0xae4000
    s_mov_b32 s5, 0xae7000
    v_lshlrev_b32 v1, 3, v0
    v_mov_b32 v3, 0
    v_lshrrev_b32 v16, 3, v0
    v_and_b32 v17, 6, v16
    v_xor_b32 v17, v17, v0
    v_and_b32 v17, 7, v17
    v_lshlrev_b32_e64 v17, 4, v17
    v_lshl_add_u32 v17, v16, 12, v17
    s_waitcnt vmcnt(0)
    s_mov_b64 exec, 1
    buffer_store_dword v28, v3, s[12:15], s30 offen sc1
    s_mov_b64 exec, -1
    s_setprio 0
    s_cmp_lg_u32 s32, 0
    s_cbranch_scc1 L_B_end
    s_mov_b32 s62, 65536
L_pfg:
    buffer_load_dwordx4 v[100:103], v2, s[12:15], s5 offen sc1
    s_waitcnt vmcnt(0)
L_pfg_chk:
    v_cmp_ne_u32 vcc, v28, v100
    v_cmp_ne_u32 s[54:55], v28, v101
    s_or_b64 vcc, vcc, s[54:55]
    v_cmp_ne_u32 s[54:55], v28, v102
    s_or_b64 vcc, vcc, s[54:55]
    v_cmp_ne_u32 s[54:55], v28, v103
    s_or_b64 vcc, vcc, s[54:55]
    s_cbranch_vccz L_pfg_ok
    s_sleep 16
    s_sub_u32 s62, s62, 1
    s_cbranch_scc0 L_pfg
L_pfg_ok:
    s_mov_b32 s62, 1048576
L_wfa:
    ds_read_b128 v[216:219], v22 offset:0
    s_waitcnt lgkmcnt(0)
    v_min3_u32 v216, v216, v217, v218
    v_min_u32 v216, v216, v219
    v_cmp_gt_u32 vcc, 26, v216
    s_cbranch_vccz L_wfa_ok
    s_sleep 2
    s_sub_u32 s62, s62, 1
    s_cbranch_scc0 L_wfa
L_wfa_ok:
    s_mov_b32 s62, 65536
L_pfa:
    buffer_load_dwordx2 v[96:97], v1, s[12:15], s39 offen sc1
    s_waitcnt vmcnt(0)
L_pfa_chk:
    v_cmp_ne_u32 vcc, v28, v96
    v_cmp_ne_u32 s[54:55], v28, v97
    s_or_b64 vcc, vcc, s[54:55]
    s_cbranch_vccz L_pfa_ok
    s_sleep 8
    s_sub_u32 s62, s62, 1
    s_cbranch_scc0 L_pfa
L_pfa_ok:
    s_lshl_b32 s36, s29, 18
    s_lshl_b32 s35, s28, 7
    s_add_u32 s36, s36, s35
    s_add_u32 s36, s36, 0x8c0000
    s_mov_b32 m0, 148480
    s_nop 0
    buffer_load_dwordx4 v17, s[12:15], s36 offen sc1 lds
    s_add_u32 s36, s36, 0x8000
    s_mov_b32 m0, 149504
    s_nop 0
    buffer_load_dwordx4 v17, s[12:15], s36 offen sc1 lds
    s_add_u32 s36, s36, 0x8000
    s_mov_b32 m0, 150528
    s_nop 0
    buffer_load_dwordx4 v17, s[12:15], s36 offen sc1 lds
    s_add_u32 s36, s36, 0x8000
    s_mov_b32 m0, 151552
    s_nop 0
    buffer_load_dwordx4 v17, s[12:15], s36 offen sc1 lds
    s_add_u32 s36, s36, 0x8000
    s_mov_b32 m0, 152576
    s_nop 0
    buffer_load_dwordx4 v17, s[12:15], s36 offen sc1 lds
    s_add_u32 s36, s36, 0x8000
    s_mov_b32 m0, 153600
    s_nop 0
    buffer_load_dwordx4 v17, s[12:15], s36 offen sc1 lds
    s_add_u32 s36, s36, 0x8000
    s_mov_b32 m0, 154624
    s_nop 0
    buffer_load_dwordx4 v17, s[12:15], s36 offen sc1 lds
    s_add_u32 s36, s36, 0x8000
    s_mov_b32 m0, 155648
    s_nop 0
    buffer_load_dwordx4 v17, s[12:15], s36 offen sc1 lds
    s_add_u32 s36, s36, 0x8000
    s_lshl_b32 s36, s28, 9
    s_add_u32 s36, s36, 0xa80000
    s_mov_b32 m0, 156672
    s_mov_b32 exec_hi, 0
    buffer_load_dwordx4 v2, s[12:15], s36 offen sc1 lds
    s_mov_b32 exec_hi, -1
    s_mov_b32 s7, 1
    s_waitcnt vmcnt(0)
L_B_end:
    s_barrier
    s_endpgm
L_helper:
    s_getpc_b64 s[36:37]
L_pc:
    s_sub_u32 s36, s36, L_pc-gated_mix__ssm_conv_s4d__mixer_gmlp__prompt_kernel
    s_subb_u32 s37, s37, 0
    s_lshl_b32 s35, s3, 13
    v_lshlrev_b32 v10, 7, v0
    v_add_u32 v10, s35, v10
    v_min_u32 v10, L_end-gated_mix__ssm_conv_s4d__mixer_gmlp__prompt_kernel, v10
    global_load_dword v29, v10, s[36:37]
    v_min_u32 v1, 55, v0
    v_lshlrev_b32 v10, 4, v1
    global_load_dwordx4 v[24:27], v10, s[54:55]
    v_lshlrev_b32 v5, 12, v0
    s_lshl_b32 s35, s28, 18
    s_lshl_b32 s22, s3, 7
    s_add_u32 s35, s35, s22
    v_add_u32 v5, s35, v5
    s_and_b32 s35, s3, 1
    s_cmp_eq_u32 s35, 1
    s_cbranch_scc0 L_H_even
    v_mov_b32 v6, v7
L_H_even:
    s_lshl_b32 s20, s28, 3
    s_add_u32 s20, s20, s3
    s_mul_i32 s20, s20, 7168
    s_lshl_b32 s21, s3, 10
    v_lshrrev_b32 v10, 3, v1
    v_lshlrev_b32 v10, 13, v10
    v_and_b32_e64 v1, 7, v1
    v_lshl_add_u32 v10, v1, 4, v10
    s_lshl_b32 s23, s28, 3
    s_add_u32 s23, s23, s3
    s_add_u32 m0, s21, 0
    s_nop 0
    buffer_load_dwordx4 v6, s[8:11], s20 offen lds
    s_add_u32 s20, s20, 128
    s_add_u32 m0, s21, 8192
    s_nop 0
    buffer_load_dwordx4 v6, s[8:11], s20 offen lds
    s_add_u32 s20, s20, 128
    s_add_u32 m0, s21, 16384
    s_nop 0
    buffer_load_dwordx4 v6, s[8:11], s20 offen lds
    s_add_u32 s20, s20, 128
    s_add_u32 m0, s21, 24576
    s_nop 0
    buffer_load_dwordx4 v6, s[8:11], s20 offen lds
    s_add_u32 s20, s20, 128
    s_add_u32 m0, s21, 32768
    s_nop 0
    buffer_load_dwordx4 v6, s[8:11], s20 offen lds
    s_add_u32 s20, s20, 128
    s_add_u32 m0, s21, 40960
    s_nop 0
    buffer_load_dwordx4 v6, s[8:11], s20 offen lds
    s_add_u32 s20, s20, 128
    s_add_u32 m0, s21, 49152
    s_nop 0
    buffer_load_dwordx4 v6, s[8:11], s20 offen lds
    s_add_u32 s20, s20, 128
    s_waitcnt vmcnt(0)
    global_load_dword v29, v5, s[48:49] offset:0
    global_load_dword v29, v5, s[48:49] offset:1024
    global_load_dword v29, v5, s[48:49] offset:2048
    global_load_dword v29, v5, s[48:49] offset:3072
    s_waitcnt lgkmcnt(0)
    s_mul_i32 s4, s4, 0x9E3779B1
    s_add_u32 s4, s4, 0x7F4A7C15
    v_mov_b32 v28, s4
    s_barrier
    s_and_b32 s35, s2, 1
    s_mul_i32 s35, s35, 3
    s_add_u32 s35, s35, s32
    s_lshl_b32 s36, s35, 11
    s_add_u32 s36, s36, 0xad0000
    s_and_b32 s37, s28, 3
    s_lshl_b32 s37, s37, 1
    s_lshr_b32 s38, s3, 2
    s_add_u32 s37, s37, s38
    s_add_u32 s37, s37, 6
    s_lshl_b32 s37, s37, 13
    s_lshl_b32 s35, s35, 19
    s_add_u32 s37, s37, s35
    s_add_u32 s38, s35, 524288
    v_lshlrev_b32 v1, 6, v0
    v_lshlrev_b32 v5, 7, v0
    s_lshl_b32 s35, s3, 2
    s_add_u32 s35, s35, 0
    s_and_b32 s35, s35, 7
    s_lshl_b32 s35, s35, 4
    v_xor_b32 v1, s35, v10
    v_add_u32 v1, s21, v1
    ds_read_b128 v[64:67], v1 offset:0
    s_lshl_b32 s35, s3, 2
    s_add_u32 s35, s35, 0
    s_and_b32 s35, s35, 7
    s_lshl_b32 s35, s35, 4
    v_xor_b32 v1, s35, v10
    v_add_u32 v1, s21, v1
    ds_read_b128 v[68:71], v1 offset:128
    s_lshl_b32 s35, s3, 2
    s_add_u32 s35, s35, 1
    s_and_b32 s35, s35, 7
    s_lshl_b32 s35, s35, 4
    v_xor_b32 v1, s35, v10
    v_add_u32 v1, s21, v1
    ds_read_b128 v[72:75], v1 offset:256
    s_lshl_b32 s35, s3, 2
    s_add_u32 s35, s35, 1
    s_and_b32 s35, s35, 7
    s_lshl_b32 s35, s35, 4
    v_xor_b32 v1, s35, v10
    v_add_u32 v1, s21, v1
    ds_read_b128 v[76:79], v1 offset:384
    s_lshl_b32 s35, s3, 2
    s_add_u32 s35, s35, 2
    s_and_b32 s35, s35, 7
    s_lshl_b32 s35, s35, 4
    v_xor_b32 v1, s35, v10
    v_add_u32 v1, s21, v1
    ds_read_b128 v[80:83], v1 offset:512
    s_lshl_b32 s35, s3, 2
    s_add_u32 s35, s35, 2
    s_and_b32 s35, s35, 7
    s_lshl_b32 s35, s35, 4
    v_xor_b32 v1, s35, v10
    v_add_u32 v1, s21, v1
    ds_read_b128 v[84:87], v1 offset:640
    s_lshl_b32 s35, s3, 2
    s_add_u32 s35, s35, 3
    s_and_b32 s35, s35, 7
    s_lshl_b32 s35, s35, 4
    v_xor_b32 v1, s35, v10
    v_add_u32 v1, s21, v1
    ds_read_b128 v[88:91], v1 offset:768
    s_lshl_b32 s35, s3, 2
    s_add_u32 s35, s35, 3
    s_and_b32 s35, s35, 7
    s_lshl_b32 s35, s35, 4
    v_xor_b32 v1, s35, v10
    v_add_u32 v1, s21, v1
    ds_read_b128 v[92:95], v1 offset:896
    v_lshlrev_b32 v16, 16, v24
    v_and_b32 v17, 0xffff0000, v24
    v_lshlrev_b32 v18, 16, v25
    v_and_b32 v19, 0xffff0000, v25
    v_lshlrev_b32_e64 v20, 16, v26
    v_and_b32 v21, 0xffff0000, v26
    v_lshlrev_b32 v22, 16, v27
    v_and_b32 v23, 0xffff0000, v27
    v_cmp_gt_u32 vcc, 56, v0
    s_waitcnt lgkmcnt(0)
    v_lshlrev_b32 v96, 16, v64
    v_and_b32 v97, 0xffff0000, v64
    v_lshlrev_b32 v98, 16, v65
    v_and_b32 v99, 0xffff0000, v65
    v_lshlrev_b32 v100, 16, v66
    v_and_b32 v101, 0xffff0000, v66
    v_lshlrev_b32_e64 v102, 16, v67
    v_and_b32 v103, 0xffff0000, v67
    v_pk_mul_f32 v[96:97], v[96:97], v[16:17]
    v_pk_mul_f32 v[98:99], v[98:99], v[18:19]
    v_pk_mul_f32 v[100:101], v[100:101], v[20:21]
    v_pk_mul_f32 v[102:103], v[102:103], v[22:23]
    v_cvt_pk_bf16_f32 v64, v96, v97
    v_cvt_pk_bf16_f32 v65, v98, v99
    v_cvt_pk_bf16_f32 v66, v100, v101
    v_cvt_pk_bf16_f32 v67, v102, v103
    v_lshlrev_b32 v96, 16, v64
    v_and_b32 v97, 0xffff0000, v64
    v_lshlrev_b32 v98, 16, v65
    v_and_b32 v99, 0xffff0000, v65
    v_lshlrev_b32 v100, 16, v66
    v_and_b32 v101, 0xffff0000, v66
    v_lshlrev_b32 v102, 16, v67
    v_and_b32 v103, 0xffff0000, v67
    v_pk_add_f32 v[96:97], v[96:97], v[98:99]
    v_pk_add_f32 v[100:101], v[100:101], v[102:103]
    v_pk_add_f32 v[96:97], v[96:97], v[100:101]
    v_add_f32 v96, v96, v97
    v_cndmask_b32 v32, 0, v96, vcc
    v_lshlrev_b32 v104, 16, v68
    v_and_b32 v105, 0xffff0000, v68
    v_lshlrev_b32 v106, 16, v69
    v_and_b32 v107, 0xffff0000, v69
    v_lshlrev_b32_e64 v108, 16, v70
    v_and_b32 v109, 0xffff0000, v70
    v_lshlrev_b32_e64 v110, 16, v71
    v_and_b32 v111, 0xffff0000, v71
    v_pk_mul_f32 v[104:105], v[104:105], v[16:17]
    v_pk_mul_f32 v[106:107], v[106:107], v[18:19]
    v_pk_mul_f32 v[108:109], v[108:109], v[20:21]
    v_pk_mul_f32 v[110:111], v[110:111], v[22:23]
    v_cvt_pk_bf16_f32 v68, v104, v105
    v_cvt_pk_bf16_f32 v69, v106, v107
    v_cvt_pk_bf16_f32 v70, v108, v109
    v_cvt_pk_bf16_f32 v71, v110, v111
    v_lshlrev_b32_e64 v104, 16, v68
    v_and_b32 v105, 0xffff0000, v68
    v_lshlrev_b32 v106, 16, v69
    v_and_b32 v107, 0xffff0000, v69
    v_lshlrev_b32 v108, 16, v70
    v_and_b32 v109, 0xffff0000, v70
    v_lshlrev_b32_e64 v110, 16, v71
    v_and_b32 v111, 0xffff0000, v71
    v_pk_add_f32 v[104:105], v[104:105], v[106:107]
    v_pk_add_f32 v[108:109], v[108:109], v[110:111]
    v_pk_add_f32 v[104:105], v[104:105], v[108:109]
    v_add_f32 v104, v104, v105
    v_cndmask_b32 v33, 0, v104, vcc
    v_lshlrev_b32 v112, 16, v72
    v_and_b32 v113, 0xffff0000, v72
    v_lshlrev_b32 v114, 16, v73
    v_and_b32 v115, 0xffff0000, v73
    v_lshlrev_b32 v116, 16, v74
    v_and_b32 v117, 0xffff0000, v74
    v_lshlrev_b32 v118, 16, v75
    v_and_b32 v119, 0xffff0000, v75
    v_pk_mul_f32 v[112:113], v[112:113], v[16:17]
    v_pk_mul_f32 v[114:115], v[114:115], v[18:19]
    v_pk_mul_f32 v[116:117], v[116:117], v[20:21]
    v_pk_mul_f32 v[118:119], v[118:119], v[22:23]
    v_cvt_pk_bf16_f32 v72, v112, v113
    v_cvt_pk_bf16_f32 v73, v114, v115
    v_cvt_pk_bf16_f32 v74, v116, v117
    v_cvt_pk_bf16_f32 v75, v118, v119
    v_lshlrev_b32 v112, 16, v72
    v_and_b32 v113, 0xffff0000, v72
    v_lshlrev_b32 v114, 16, v73
    v_and_b32 v115, 0xffff0000, v73
    v_lshlrev_b32_e64 v116, 16, v74
    v_and_b32 v117, 0xffff0000, v74
    v_lshlrev_b32_e64 v118, 16, v75
    v_and_b32 v119, 0xffff0000, v75
    v_pk_add_f32 v[112:113], v[112:113], v[114:115]
    v_pk_add_f32 v[116:117], v[116:117], v[118:119]
    v_pk_add_f32 v[112:113], v[112:113], v[116:117]
    v_add_f32 v112, v112, v113
    v_cndmask_b32 v34, 0, v112, vcc
    v_lshlrev_b32_e64 v120, 16, v76
    v_and_b32 v121, 0xffff0000, v76
    v_lshlrev_b32 v122, 16, v77
    v_and_b32 v123, 0xffff0000, v77
    v_lshlrev_b32 v124, 16, v78
    v_and_b32 v125, 0xffff0000, v78
    v_lshlrev_b32_e64 v126, 16, v79
    v_and_b32 v127, 0xffff0000, v79
    v_pk_mul_f32 v[120:121], v[120:121], v[16:17]
    v_pk_mul_f32 v[122:123], v[122:123], v[18:19]
    v_pk_mul_f32 v[124:125], v[124:125], v[20:21]
    v_pk_mul_f32 v[126:127], v[126:127], v[22:23]
    v_cvt_pk_bf16_f32 v76, v120, v121
    v_cvt_pk_bf16_f32 v77, v122, v123
    v_cvt_pk_bf16_f32 v78, v124, v125
    v_cvt_pk_bf16_f32 v79, v126, v127
    v_lshlrev_b32 v120, 16, v76
    v_and_b32 v121, 0xffff0000, v76
    v_lshlrev_b32 v122, 16, v77
    v_and_b32 v123, 0xffff0000, v77
    v_lshlrev_b32 v124, 16, v78
    v_and_b32 v125, 0xffff0000, v78
    v_lshlrev_b32 v126, 16, v79
    v_and_b32 v127, 0xffff0000, v79
    v_pk_add_f32 v[120:121], v[120:121], v[122:123]
    v_pk_add_f32 v[124:125], v[124:125], v[126:127]
    v_pk_add_f32 v[120:121], v[120:121], v[124:125]
    v_add_f32 v120, v120, v121
    v_cndmask_b32 v35, 0, v120, vcc
    v_lshlrev_b32 v128, 16, v80
    v_and_b32 v129, 0xffff0000, v80
    v_lshlrev_b32 v130, 16, v81
    v_and_b32 v131, 0xffff0000, v81
    v_lshlrev_b32_e64 v132, 16, v82
    v_and_b32 v133, 0xffff0000, v82
    v_lshlrev_b32_e64 v134, 16, v83
    v_and_b32 v135, 0xffff0000, v83
    v_pk_mul_f32 v[128:129], v[128:129], v[16:17]
    v_pk_mul_f32 v[130:131], v[130:131], v[18:19]
    v_pk_mul_f32 v[132:133], v[132:133], v[20:21]
    v_pk_mul_f32 v[134:135], v[134:135], v[22:23]
    v_cvt_pk_bf16_f32 v80, v128, v129
    v_cvt_pk_bf16_f32 v81, v130, v131
    v_cvt_pk_bf16_f32 v82, v132, v133
    v_cvt_pk_bf16_f32 v83, v134, v135
    v_lshlrev_b32_e64 v128, 16, v80
    v_and_b32 v129, 0xffff0000, v80
    v_lshlrev_b32 v130, 16, v81
    v_and_b32 v131, 0xffff0000, v81
    v_lshlrev_b32 v132, 16, v82
    v_and_b32 v133, 0xffff0000, v82
    v_lshlrev_b32_e64 v134, 16, v83
    v_and_b32 v135, 0xffff0000, v83
    v_pk_add_f32 v[128:129], v[128:129], v[130:131]
    v_pk_add_f32 v[132:133], v[132:133], v[134:135]
    v_pk_add_f32 v[128:129], v[128:129], v[132:133]
    v_add_f32 v128, v128, v129
    v_cndmask_b32 v36, 0, v128, vcc
    v_lshlrev_b32 v136, 16, v84
    v_and_b32 v137, 0xffff0000, v84
    v_lshlrev_b32 v138, 16, v85
    v_and_b32 v139, 0xffff0000, v85
    v_lshlrev_b32 v140, 16, v86
    v_and_b32 v141, 0xffff0000, v86
    v_lshlrev_b32 v142, 16, v87
    v_and_b32 v143, 0xffff0000, v87
    v_pk_mul_f32 v[136:137], v[136:137], v[16:17]
    v_pk_mul_f32 v[138:139], v[138:139], v[18:19]
    v_pk_mul_f32 v[140:141], v[140:141], v[20:21]
    v_pk_mul_f32 v[142:143], v[142:143], v[22:23]
    v_cvt_pk_bf16_f32 v84, v136, v137
    v_cvt_pk_bf16_f32 v85, v138, v139
    v_cvt_pk_bf16_f32 v86, v140, v141
    v_cvt_pk_bf16_f32 v87, v142, v143
    v_lshlrev_b32 v136, 16, v84
    v_and_b32 v137, 0xffff0000, v84
    v_lshlrev_b32 v138, 16, v85
    v_and_b32 v139, 0xffff0000, v85
    v_lshlrev_b32_e64 v140, 16, v86
    v_and_b32 v141, 0xffff0000, v86
    v_lshlrev_b32_e64 v142, 16, v87
    v_and_b32 v143, 0xffff0000, v87
    v_pk_add_f32 v[136:137], v[136:137], v[138:139]
    v_pk_add_f32 v[140:141], v[140:141], v[142:143]
    v_pk_add_f32 v[136:137], v[136:137], v[140:141]
    v_add_f32 v136, v136, v137
    v_cndmask_b32 v37, 0, v136, vcc
    v_lshlrev_b32_e64 v144, 16, v88
    v_and_b32 v145, 0xffff0000, v88
    v_lshlrev_b32 v146, 16, v89
    v_and_b32 v147, 0xffff0000, v89
    v_lshlrev_b32 v148, 16, v90
    v_and_b32 v149, 0xffff0000, v90
    v_lshlrev_b32_e64 v150, 16, v91
    v_and_b32 v151, 0xffff0000, v91
    v_pk_mul_f32 v[144:145], v[144:145], v[16:17]
    v_pk_mul_f32 v[146:147], v[146:147], v[18:19]
    v_pk_mul_f32 v[148:149], v[148:149], v[20:21]
    v_pk_mul_f32 v[150:151], v[150:151], v[22:23]
    v_cvt_pk_bf16_f32 v88, v144, v145
    v_cvt_pk_bf16_f32 v89, v146, v147
    v_cvt_pk_bf16_f32 v90, v148, v149
    v_cvt_pk_bf16_f32 v91, v150, v151
    v_lshlrev_b32 v144, 16, v88
    v_and_b32 v145, 0xffff0000, v88
    v_lshlrev_b32 v146, 16, v89
    v_and_b32 v147, 0xffff0000, v89
    v_lshlrev_b32 v148, 16, v90
    v_and_b32 v149, 0xffff0000, v90
    v_lshlrev_b32 v150, 16, v91
    v_and_b32 v151, 0xffff0000, v91
    v_pk_add_f32 v[144:145], v[144:145], v[146:147]
    v_pk_add_f32 v[148:149], v[148:149], v[150:151]
    v_pk_add_f32 v[144:145], v[144:145], v[148:149]
    v_add_f32 v144, v144, v145
    v_cndmask_b32 v38, 0, v144, vcc
    v_lshlrev_b32 v152, 16, v92
    v_and_b32 v153, 0xffff0000, v92
    v_lshlrev_b32 v154, 16, v93
    v_and_b32 v155, 0xffff0000, v93
    v_lshlrev_b32_e64 v156, 16, v94
    v_and_b32 v157, 0xffff0000, v94
    v_lshlrev_b32_e64 v158, 16, v95
    v_and_b32 v159, 0xffff0000, v95
    v_pk_mul_f32 v[152:153], v[152:153], v[16:17]
    v_pk_mul_f32 v[154:155], v[154:155], v[18:19]
    v_pk_mul_f32 v[156:157], v[156:157], v[20:21]
    v_pk_mul_f32 v[158:159], v[158:159], v[22:23]
    v_cvt_pk_bf16_f32 v92, v152, v153
    v_cvt_pk_bf16_f32 v93, v154, v155
    v_cvt_pk_bf16_f32 v94, v156, v157
    v_cvt_pk_bf16_f32 v95, v158, v159
    v_lshlrev_b32_e64 v152, 16, v92
    v_and_b32 v153, 0xffff0000, v92
    v_lshlrev_b32 v154, 16, v93
    v_and_b32 v155, 0xffff0000, v93
    v_lshlrev_b32 v156, 16, v94
    v_and_b32 v157, 0xffff0000, v94
    v_lshlrev_b32_e64 v158, 16, v95
    v_and_b32 v159, 0xffff0000, v95
    v_pk_add_f32 v[152:153], v[152:153], v[154:155]
    v_pk_add_f32 v[156:157], v[156:157], v[158:159]
    v_pk_add_f32 v[152:153], v[152:153], v[156:157]
    v_add_f32 v152, v152, v153
    v_cndmask_b32 v39, 0, v152, vcc
    v_add_f32_dpp v32, v32, v32 row_ror:8 row_mask:0xf bank_mask:0xf
    v_add_f32_dpp v33, v33, v33 row_ror:8 row_mask:0xf bank_mask:0xf
    v_add_f32_dpp v34, v34, v34 row_ror:8 row_mask:0xf bank_mask:0xf
    v_add_f32_dpp v35, v35, v35 row_ror:8 row_mask:0xf bank_mask:0xf
    v_add_f32_dpp v36, v36, v36 row_ror:8 row_mask:0xf bank_mask:0xf
    v_add_f32_dpp v37, v37, v37 row_ror:8 row_mask:0xf bank_mask:0xf
    v_add_f32_dpp v38, v38, v38 row_ror:8 row_mask:0xf bank_mask:0xf
    v_add_f32_dpp v39, v39, v39 row_ror:8 row_mask:0xf bank_mask:0xf
    v_add_f32_dpp v32, v32, v32 row_ror:4 row_mask:0xf bank_mask:0xf
    v_add_f32_dpp v33, v33, v33 row_ror:4 row_mask:0xf bank_mask:0xf
    v_add_f32_dpp v34, v34, v34 row_ror:4 row_mask:0xf bank_mask:0xf
    v_add_f32_dpp v35, v35, v35 row_ror:4 row_mask:0xf bank_mask:0xf
    v_add_f32_dpp v36, v36, v36 row_ror:4 row_mask:0xf bank_mask:0xf
    v_add_f32_dpp v37, v37, v37 row_ror:4 row_mask:0xf bank_mask:0xf
    v_add_f32_dpp v38, v38, v38 row_ror:4 row_mask:0xf bank_mask:0xf
    v_add_f32_dpp v39, v39, v39 row_ror:4 row_mask:0xf bank_mask:0xf
    v_add_f32_dpp v32, v32, v32 row_ror:2 row_mask:0xf bank_mask:0xf
    v_add_f32_dpp v33, v33, v33 row_ror:2 row_mask:0xf bank_mask:0xf
    v_add_f32_dpp v34, v34, v34 row_ror:2 row_mask:0xf bank_mask:0xf
    v_add_f32_dpp v35, v35, v35 row_ror:2 row_mask:0xf bank_mask:0xf
    v_add_f32_dpp v36, v36, v36 row_ror:2 row_mask:0xf bank_mask:0xf
    v_add_f32_dpp v37, v37, v37 row_ror:2 row_mask:0xf bank_mask:0xf
    v_add_f32_dpp v38, v38, v38 row_ror:2 row_mask:0xf bank_mask:0xf
    v_add_f32_dpp v39, v39, v39 row_ror:2 row_mask:0xf bank_mask:0xf
    v_add_f32_dpp v32, v32, v32 row_ror:1 row_mask:0xf bank_mask:0xf
    v_add_f32_dpp v33, v33, v33 row_ror:1 row_mask:0xf bank_mask:0xf
    v_add_f32_dpp v34, v34, v34 row_ror:1 row_mask:0xf bank_mask:0xf
    v_add_f32_dpp v35, v35, v35 row_ror:1 row_mask:0xf bank_mask:0xf
    v_add_f32_dpp v36, v36, v36 row_ror:1 row_mask:0xf bank_mask:0xf
    v_add_f32_dpp v37, v37, v37 row_ror:1 row_mask:0xf bank_mask:0xf
    v_add_f32_dpp v38, v38, v38 row_ror:1 row_mask:0xf bank_mask:0xf
    v_add_f32_dpp v39, v39, v39 row_ror:1 row_mask:0xf bank_mask:0xf
    v_mov_b32 v40, v32
    v_mov_b32 v41, v33
    v_mov_b32 v42, v34
    v_mov_b32 v43, v35
    v_mov_b32 v44, v36
    v_mov_b32 v45, v37
    v_mov_b32 v46, v38
    v_mov_b32 v47, v39
    v_permlane16_swap_b32 v32, v40
    v_permlane16_swap_b32 v33, v41
    v_permlane16_swap_b32 v34, v42
    v_permlane16_swap_b32 v35, v43
    v_permlane16_swap_b32 v36, v44
    v_permlane16_swap_b32 v37, v45
    v_permlane16_swap_b32 v38, v46
    v_permlane16_swap_b32 v39, v47
    v_add_f32 v32, v32, v40
    v_add_f32 v33, v33, v41
    v_add_f32 v34, v34, v42
    v_add_f32 v35, v35, v43
    v_add_f32 v36, v36, v44
    v_add_f32 v37, v37, v45
    v_add_f32 v38, v38, v46
    v_add_f32 v39, v39, v47
    v_mov_b32 v40, v32
    v_mov_b32 v41, v33
    v_mov_b32 v42, v34
    v_mov_b32 v43, v35
    v_mov_b32 v44, v36
    v_mov_b32 v45, v37
    v_mov_b32 v46, v38
    v_mov_b32 v47, v39
    v_permlane32_swap_b32 v32, v40
    v_permlane32_swap_b32 v33, v41
    v_permlane32_swap_b32 v34, v42
    v_permlane32_swap_b32 v35, v43
    v_permlane32_swap_b32 v36, v44
    v_permlane32_swap_b32 v37, v45
    v_permlane32_swap_b32 v38, v46
    v_permlane32_swap_b32 v39, v47
    v_add_f32 v32, v32, v40
    v_add_f32 v33, v33, v41
    v_add_f32 v34, v34, v42
    v_add_f32 v35, v35, v43
    v_add_f32 v36, v36, v44
    v_add_f32 v37, v37, v45
    v_add_f32 v38, v38, v46
    v_add_f32 v39, v39, v47
    v_cmp_eq_u32 vcc, 1, v0
    s_nop 1
    v_cndmask_b32 v32, v32, v33, vcc
    v_cmp_eq_u32 vcc, 2, v0
    s_nop 1
    v_cndmask_b32 v32, v32, v34, vcc
    v_cmp_eq_u32 vcc, 3, v0
    s_nop 1
    v_cndmask_b32 v32, v32, v35, vcc
    v_cmp_eq_u32 vcc, 4, v0
    s_nop 1
    v_cndmask_b32 v32, v32, v36, vcc
    v_cmp_eq_u32 vcc, 5, v0
    s_nop 1
    v_cndmask_b32 v32, v32, v37, vcc
    v_cmp_eq_u32 vcc, 6, v0
    s_nop 1
    v_cndmask_b32 v32, v32, v38, vcc
    v_cmp_eq_u32 vcc, 7, v0
    s_nop 1
    v_cndmask_b32 v32, v32, v39, vcc
    v_cvt_pk_bf16_f32 v32, v32, v32
    v_lshlrev_b32 v32, 16, v32
    v_mul_f32 v32, 0xbfb8aa3b, v32
    v_exp_f32 v32, v32
    s_nop 0
    v_add_f32 v32, 1.0, v32
    v_rcp_f32 v32, v32
    s_nop 0
    v_cvt_pk_bf16_f32 v32, v32, v32
    v_lshlrev_b32 v32, 16, v32
    v_sub_f32_e64 v33, 1.0, v32
    v_cvt_pk_bf16_f32 v33, v33, v33
    v_lshlrev_b32_e64 v33, 16, v33
    s_lshl_b32 s36, s23, 6
    s_add_u32 s36, s36, 0xa80000
    s_lshl_b32 s35, s23, 2
    s_add_u32 s35, s35, 0xae7000
    v_lshlrev_b32 v1, 3, v0
    s_mov_b64 exec, 0xff
    buffer_store_dwordx2 v[32:33], v1, s[12:15], s36 offen sc1
    s_waitcnt vmcnt(0)
    s_mov_b64 exec, 1
    buffer_store_dword v28, v1, s[12:15], s35 offen sc1
    s_mov_b64 exec, -1
    s_and_b32 s35, s28, 3
    s_lshl_b32 s35, s35, 3
    s_add_u32 s35, s35, s3
    s_mul_i32 s35, s35, 25088
    s_and_b32 s36, s2, 1
    s_mul_i32 s36, s36, 384
    s_add_u32 s35, s35, s36
    v_min_u32 v5, 55, v0
    v_lshrrev_b32_e64 v1, 2, v5
    v_mul_u32_u24 v1, 896, v1
    v_and_b32 v5, 3, v5
    v_lshl_add_u32 v5, v5, 7, v1
    v_add_u32 v5, s35, v5
    global_load_dword v29, v5, s[52:53]
    v_add_u32 v5, 12544, v5
    global_load_dword v29, v5, s[52:53]
L_end:
    s_endpgm
.section .rodata,"a"

.p2align 6
.amdhsa_kernel gated_mix__ssm_conv_s4d__mixer_gmlp__prompt_kernel
  .amdhsa_next_free_vgpr 256
  .amdhsa_next_free_sgpr 64
  .amdhsa_accum_offset 256
  .amdhsa_group_segment_fixed_size 0
  .amdhsa_kernarg_size 128
  .amdhsa_user_sgpr_count 2
  .amdhsa_user_sgpr_kernarg_segment_ptr 1
  .amdhsa_system_sgpr_workgroup_id_x 1
.end_amdhsa_kernel
```
